```python
import torch

def _softmax(x, axis=-1):
    return torch.softmax(x, dim=axis)

def _gelu(x):
    return torch.nn.functional.gelu(x, approximate='tanh')

def _silu(x):
    return torch.nn.functional.silu(x)

def _sigmoid(x):
    return torch.sigmoid(x)

def _layernorm(x, axis=-1, eps=1e-05):
    m = x.mean(dim=axis, keepdim=True)
    v = x.var(dim=axis, keepdim=True, unbiased=False)
    return (x - m) / torch.sqrt(v + eps)

def _scatter_add(tgt, idx, src, axis=0):
    return tgt.clone().index_add_(axis, idx, src)

def _segment_sum(src, seg, n):
    out = torch.zeros((n,) + src.shape[1:], dtype=src.dtype)
    return out.index_add_(0, seg, src)

def _pad(x, pw):
    flat = tuple((v for pair in reversed(pw) for v in pair))
    return torch.nn.functional.pad(x, flat)
kernel_name = 'adaLN_cond__gqa_block_cached__mixer_token_mlp__decode'

def setup_inputs():

    _w = lambda a: (lambda t: t.to(torch.bfloat16) if t.is_floating_point() else t)(torch.as_tensor(a))

    def _A_setup():
        B, Sq, D = (2, 1, 1024)
        Hq, Hkv, Sk, Dh = (32, 4, 32768, 128)
        assert Hq % Hkv == 0, (Hq, Hkv)
        return {'x': _w((lambda *s: torch.randn(*s, dtype=torch.bfloat16) * 0.05)(B, Sq, D)), 'k_cache': _w((lambda *s: torch.randn(*s, dtype=torch.bfloat16) * 3.2)(B, Hkv, Sk, Dh)), 'v_cache': _w((lambda *s: torch.randn(*s, dtype=torch.bfloat16) * 1.6)(B, Hkv, Sk, Dh)), 'wq': _w((lambda *s: torch.randn(*s, dtype=torch.bfloat16) * 3.2)(D, Hq * Dh) * D ** (-0.5)), 'wo': _w((lambda *s: torch.randn(*s, dtype=torch.bfloat16) * 1.6)(Hq * Dh, D) * (Hq * Dh) ** (-0.5))}
    _A_in = _A_setup()

    def _B_setup():
        B, S, D, F = (2, 1, 1024, 3584)
        return {'x': _w((lambda *s: torch.randn(*s, dtype=torch.bfloat16) * 0.05)(B, S, D)), 'w1': _w((lambda *s: torch.randn(*s, dtype=torch.bfloat16) * 1.6)(S, F) * S ** (-0.5)), 'b1': _w((lambda *s: torch.randn(*s, dtype=torch.bfloat16) * 1.6)(F) * 0.02), 'w2': _w((lambda *s: torch.randn(*s, dtype=torch.bfloat16) * 1.6)(F, S) * F ** (-0.5)), 'b2': _w((lambda *s: torch.randn(*s, dtype=torch.bfloat16) * 1.6)(S) * 0.02)}
    _B_in = _B_setup()
    return {'A_x': _A_in['x'], 'A_k_cache': _A_in['k_cache'], 'A_v_cache': _A_in['v_cache'], 'A_wq': _A_in['wq'], 'A_wo': _A_in['wo'], 'B_x': _B_in['x'], 'B_w1': _B_in['w1'], 'B_b1': _B_in['b1'], 'B_w2': _B_in['w2'], 'B_b2': _B_in['b2'], 'c': _w((lambda *s: torch.randn(*s, dtype=torch.bfloat16) * 0.05)(2, 1024) * 8.0), 'w_mod': _w((lambda *s: torch.randn(*s, dtype=torch.bfloat16) * 0.05)(1024, 6 * 1024) * 1024 ** (-0.5) * 8.0)}

def reference(A_x, A_k_cache, A_v_cache, A_wq, A_wo, B_x, B_w1, B_b1, B_w2, B_b2, c, w_mod):

    def _A_ref(x, k_cache, v_cache, wq, wo):
        B, Sq, D = x.shape
        Hq, Dh = (32, 128)
        Hkv = k_cache.shape[1]
        rep = Hq // Hkv
        q = (lambda x, *d: x.permute(*d))((x @ wq).reshape(B, Sq, Hq, Dh), 0, 2, 1, 3)
        k = (lambda x, n, axis: torch.repeat_interleave(x, n, dim=axis))(k_cache, rep, axis=1)
        v = (lambda x, n, axis: torch.repeat_interleave(x, n, dim=axis))(v_cache, rep, axis=1)
        scores = torch.einsum('bhqd,bhkd->bhqk', q, k) * Dh ** (-0.5)
        p = _softmax(scores, axis=-1)
        o = torch.einsum('bhqk,bhkd->bhqd', p, v)
        return (lambda x, *d: x.permute(*d))(o, 0, 2, 1, 3).reshape(B, Sq, Hq * Dh) @ wo

    def _B_ref(x, w1, b1, w2, b2):
        B, S, D = x.shape
        h = _layernorm(x, axis=-1)
        u = torch.einsum('bsd,sf->bdf', h, w1) + b1
        u = _gelu(u)
        y = torch.einsum('bdf,fs->bds', u, w2) + b2
        return (lambda x, *d: x.permute(*d))(y, 0, 2, 1)
    x = A_x
    mod = (_silu(c) @ w_mod).reshape(c.shape[0], 6, 1, -1)
    sa, ca, ga, sb, cb, gb = (mod[:, 0].clone(), mod[:, 1].clone(), mod[:, 2].clone(), mod[:, 3].clone(), mod[:, 4].clone(), mod[:, 5].clone())
    h = _layernorm(x, axis=-1) * (1 + ca) + sa
    x = x + ga * _A_ref(h, A_k_cache, A_v_cache, A_wq, A_wo)
    h = _layernorm(x, axis=-1) * (1 + cb) + sb
    x = x + gb * _B_ref(h, B_w1, B_b1, B_w2, B_b2)
    return x
```

```asm
; @launch grid=(256,1,1) block=(512,1,1) lds=145408
.amdgcn_target "amdgcn-amd-amdhsa--gfx950"
.text
.globl adaLN_cond__gqa_block_cached__mixer_token_mlp__decode_kernel
.p2align 8
.type adaLN_cond__gqa_block_cached__mixer_token_mlp__decode_kernel,@function
adaLN_cond__gqa_block_cached__mixer_token_mlp__decode_kernel:
    s_cmp_ge_u32 s2, 256
    s_cbranch_scc1 L_end
    s_load_dwordx16 s[16:31], s[0:1], 0
    s_load_dwordx8 s[32:39], s[0:1], 64
    s_load_dwordx4 s[40:43], s[0:1], 96
    s_load_dwordx2 s[44:45], s[0:1], 112
    v_lshlrev_b32 v47, 7, v0
    v_cmp_gt_u32 vcc, L_end-adaLN_cond__gqa_block_cached__mixer_token_mlp__decode_kernel, v47
    s_cbranch_vccz PCD_2
    s_getpc_b64 s[72:73]
PC_1:
    s_sub_u32 s72, s72, PC_1-adaLN_cond__gqa_block_cached__mixer_token_mlp__decode_kernel
    s_subb_u32 s73, s73, 0
    s_mov_b64 exec, vcc
    global_load_dword v47, v47, s[72:73]
    s_mov_b64 exec, -1
PCD_2:
    v_lshrrev_b32 v4, 6, v0
    v_and_b32 v1, 63, v0
    v_readfirstlane_b32 s3, v4
    v_lshrrev_b32 v2, 4, v1
    v_and_b32 v3, 15, v1
    v_mov_b32 v4, 0
    v_mov_b32 v5, 0
    v_mov_b32 v6, 0
    v_mov_b32 v7, 0
    v_lshlrev_b32 v8, 4, v0
    ds_write_b128 v8, v[4:7]
    s_and_b32 s5, s2, 7
    s_lshr_b32 s6, s2, 3
    s_mov_b32 s10, 400000
    s_mov_b32 s47, 0
    s_mov_b32 s11, 0x05040100
    s_mov_b32 s12, 0x07060302
    s_mov_b32 s14, 0x3fb8aa3b
    s_mov_b32 s15, 0x3db504f3
    s_mov_b32 s68, 0xffff0000
    s_mov_b32 s69, 0xffff0000
    s_mov_b32 s70, 0
    s_mov_b32 s71, -1
    s_lshl_b32 s13, s5, 23
    s_lshl_b32 s7, s6, 18
    s_add_u32 s13, s13, s7
    s_lshl_b32 s7, s3, 15
    s_add_u32 s13, s13, s7
    v_lshrrev_b32 v9, 1, v3
    v_lshlrev_b32 v9, 8, v9
    v_lshl_add_u32 v9, v2, 5, v9
    v_and_b32 v10, 1, v3
    v_lshl_add_u32 v9, v10, 4, v9
    v_mov_b32 v158, 0
    v_mov_b32 v159, 0
    v_mov_b32 v13, 0
    v_mov_b32 v11, 0
    v_mov_b32 v10, 0
    v_mov_b32 v45, 0
    v_mov_b32 v46, 0
    v_mov_b32 v120, -1
    v_mov_b32 v121, -1
    v_mov_b32 v122, -1
    v_mov_b32 v123, -1
    v_lshlrev_b32 v124, 4, v1
    s_mul_i32 s8, s2, 2624
    s_add_u32 s8, s8, 1048576
    s_waitcnt lgkmcnt(0)
    s_mov_b32 s48, s18
    s_mov_b32 s49, s19
    s_mov_b32 s50, 67108864
    s_mov_b32 s51, 0x20000
    s_cmp_lg_u32 s3, 2
    s_cbranch_scc1 L_nok0
    s_add_u32 s7, s13, 0
    buffer_load_dwordx4 v[128:131], v9, s[48:51], s7 offen offset:0 nt
    buffer_load_dwordx4 v[132:135], v9, s[48:51], s7 offen offset:128 nt
    buffer_load_dwordx4 v[136:139], v9, s[48:51], s7 offen offset:2048 nt
    buffer_load_dwordx4 v[140:143], v9, s[48:51], s7 offen offset:2176 nt
    s_add_u32 s7, s13, 4096
    buffer_load_dwordx4 v[144:147], v9, s[48:51], s7 offen offset:0 nt
    buffer_load_dwordx4 v[148:151], v9, s[48:51], s7 offen offset:128 nt
    buffer_load_dwordx4 v[152:155], v9, s[48:51], s7 offen offset:2048 nt
    buffer_load_dwordx4 v[156:159], v9, s[48:51], s7 offen offset:2176 nt
    s_add_u32 s7, s13, 8192
    buffer_load_dwordx4 v[160:163], v9, s[48:51], s7 offen offset:0 nt
    buffer_load_dwordx4 v[164:167], v9, s[48:51], s7 offen offset:128 nt
    buffer_load_dwordx4 v[168:171], v9, s[48:51], s7 offen offset:2048 nt
    buffer_load_dwordx4 v[172:175], v9, s[48:51], s7 offen offset:2176 nt
L_nok0:
    s_mov_b32 s56, s44
    s_mov_b32 s57, s45
    s_mov_b32 s58, 268435456
    s_mov_b32 s59, 0x20000
    s_cmp_lg_u32 s3, 4
    s_cbranch_scc1 L_noclr
    buffer_store_dwordx4 v[120:123], v124, s[56:59], s8 offen sc1
    buffer_store_dwordx4 v[120:123], v124, s[56:59], s8 offen offset:1024 sc1
    s_mov_b32 exec_hi, 15
    buffer_store_dwordx4 v[120:123], v124, s[56:59], s8 offen offset:2048 sc1
    s_mul_i32 s8, s2, 1280
    s_add_u32 s8, s8, 524288
    s_mov_b64 exec, 0xff
    buffer_store_dwordx4 v[120:123], v124, s[56:59], s8 offen sc1
    s_mov_b64 exec, -1
L_noclr:
    s_cmp_lg_u32 s3, 3
    s_cbranch_scc1 L_nopf
    s_mov_b32 s60, s38
    s_mov_b32 s61, s39
    s_mov_b32 s62, 12582912
    s_mov_b32 s63, 0x20000
    s_mov_b32 s64, s22
    s_mov_b32 s65, s23
    s_mov_b32 s66, 8388608
    s_mov_b32 s67, 0x20000
    v_lshrrev_b32 v8, 2, v1
    v_mul_u32_u24 v8, 12288, v8
    v_and_b32 v9, 3, v1
    v_lshl_add_u32 v8, v9, 7, v8
    s_mul_i32 s9, s6, 393216
    s_lshl_b32 s7, s5, 9
    s_add_u32 s7, s7, s9
    s_add_u32 s8, s7, 196608
    buffer_load_dword v12, v8, s[60:63], s7 offen
    buffer_load_dword v13, v8, s[60:63], s8 offen
    s_sub_u32 s9, s6, 4
    s_cmp_ge_u32 s9, 8
    s_cbranch_scc1 L_nopf
    v_lshlrev_b32 v9, 13, v1
    v_mul_u32_u24 v10, 12288, v1
    s_lshl_b32 s7, s9, 20
    s_lshl_b32 s8, s5, 10
    s_add_u32 s7, s7, s8
    buffer_load_dword v14, v9, s[64:67], s7 offen offset:384
    s_add_u32 s7, s7, 524288
    buffer_load_dword v15, v9, s[64:67], s7 offen offset:384
    s_mul_i32 s7, s9, 1572864
    s_xor_b32 s8, s8, 1024
    s_add_u32 s7, s7, s8
    s_add_u32 s7, s7, 4096
    buffer_load_dword v16, v10, s[60:63], s7 offen offset:384
    s_add_u32 s7, s7, 786432
    buffer_load_dword v17, v10, s[60:63], s7 offen offset:384
L_nopf:
    s_mov_b32 s52, s20
    s_mov_b32 s53, s21
    s_mov_b32 s54, 67108864
    s_mov_b32 s55, 0x20000
    s_cmp_lt_u32 s6, 4
    s_cselect_b32 s0, 2, 0
    s_lshr_b32 s42, s6, 4
    s_and_b32 s7, s6, 0x17
    s_cmp_eq_u32 s7, 0x13
    s_cselect_b32 s1, 2, s0
    s_cselect_b32 s42, 0, s42
    s_barrier
    s_cmp_eq_u32 s3, 2
    s_cbranch_scc1 L_stream
    s_cmp_eq_u32 s3, 3
    s_cbranch_scc1 L_w6
    s_cmp_gt_u32 s3, 5
    s_cbranch_scc1 L_w45
    s_cmp_eq_u32 s3, 5
    s_cbranch_scc1 L_tab
    s_cmp_eq_u32 s3, 4
    s_cbranch_scc1 L_w27
    s_or_b32 s7, s1, s42
    s_cbranch_scc0 L_norole
    s_setprio 3
    s_lshr_b32 s8, s6, 3
    s_cmp_eq_u32 s8, 2
    s_cselect_b32 s47, 1, 0
    s_cselect_b32 s60, s22, s38
    s_cselect_b32 s61, s23, s39
    s_mov_b32 s8, 12582912
    s_cselect_b32 s62, 8388608, s8
    s_mov_b32 s63, 0x20000
    s_movk_i32 s8, 0x3000
    s_cselect_b32 s4, 0x2000, s8
    s_cselect_b32 s8, 0, 1
    s_cselect_b32 s9, 0, 32
    s_xor_b32 s8, s5, s8
    s_lshl_b32 s8, s8, 3
    s_and_b32 s7, s6, 7
    s_add_u32 s7, s7, s8
    s_add_u32 s7, s7, s9
    s_lshl_b32 s8, s5, 2
    s_add_u32 s8, s8, s6
    s_cmp_lt_u32 s6, 4
    s_cselect_b32 s9, s8, s7
    s_mul_i32 s27, s47, 96
    s_add_u32 s27, s27, s9
    v_lshrrev_b32 v36, 3, v3
    v_lshlrev_b32 v36, 2, v36
    v_add_lshl_u32 v36, v36, v2, 3
    v_mul_lo_u32 v36, v36, s4
    v_and_b32 v37, 7, v3
    v_lshl_add_u32 v36, v37, 4, v36
    s_lshl_b32 s7, s3, 9
    s_mul_i32 s7, s7, s4
    s_lshl_b32 s9, s9, 7
    s_add_u32 s72, s7, s9
    s_add_u32 s73, s72, s4
    s_add_u32 s74, s73, s4
    s_add_u32 s75, s74, s4
    s_add_u32 s76, s75, s4
    s_add_u32 s77, s76, s4
    s_add_u32 s78, s77, s4
    s_add_u32 s79, s78, s4
    s_lshl_b32 s4, s4, 6
    s_lshl_b32 s9, s3, 15
    s_add_u32 s9, s9, 14336
    v_lshl_add_u32 v37, v1, 4, s9
    s_cmp_gt_u32 s42, s47
    s_cselect_b64 vcc, -1, 0
    s_cmp_lg_u32 s42, 0
    s_cbranch_scc1 L_tile2
    s_load_dword s46, s[34:35], 0
    s_load_dword s26, s[44:45], 327680
    s_waitcnt lgkmcnt(0)
    s_mul_i32 s26, s26, 0x9e3779b1
    s_add_u32 s26, s26, 0x7f4a7c15
    s_cmp_eq_u32 s0, 0
    s_cselect_b32 s8, 13, 4
    v_mov_b32 v39, 0
LW_3:
    ds_read_b32 v38, v39 offset:228
    s_waitcnt lgkmcnt(0)
    v_readfirstlane_b32 s7, v38
    s_cmp_ge_u32 s7, s8
    s_cbranch_scc1 LWD_4
    s_sleep 1
    s_sub_u32 s10, s10, 1
    s_cbranch_scc0 LW_3
    s_mov_b32 s10, 0
LWD_4:
    s_nop 4
L_tile2:
    buffer_load_dwordx4 v[128:131], v36, s[60:63], s72 offen nt
    buffer_load_dwordx4 v[132:135], v36, s[60:63], s73 offen nt
    buffer_load_dwordx4 v[136:139], v36, s[60:63], s74 offen nt
    buffer_load_dwordx4 v[140:143], v36, s[60:63], s75 offen nt
    buffer_load_dwordx4 v[144:147], v36, s[60:63], s76 offen nt
    buffer_load_dwordx4 v[148:151], v36, s[60:63], s77 offen nt
    buffer_load_dwordx4 v[152:155], v36, s[60:63], s78 offen nt
    buffer_load_dwordx4 v[156:159], v36, s[60:63], s79 offen nt
    v_add_u32 v36, s4, v36
    buffer_load_dwordx4 v[160:163], v36, s[60:63], s72 offen nt
    buffer_load_dwordx4 v[164:167], v36, s[60:63], s73 offen nt
    buffer_load_dwordx4 v[168:171], v36, s[60:63], s74 offen nt
    buffer_load_dwordx4 v[172:175], v36, s[60:63], s75 offen nt
    buffer_load_dwordx4 v[176:179], v36, s[60:63], s76 offen nt
    buffer_load_dwordx4 v[180:183], v36, s[60:63], s77 offen nt
    buffer_load_dwordx4 v[184:187], v36, s[60:63], s78 offen nt
    buffer_load_dwordx4 v[188:191], v36, s[60:63], s79 offen nt
    v_add_u32 v36, s4, v36
    buffer_load_dwordx4 v[192:195], v36, s[60:63], s72 offen nt
    buffer_load_dwordx4 v[196:199], v36, s[60:63], s73 offen nt
    buffer_load_dwordx4 v[200:203], v36, s[60:63], s74 offen nt
    buffer_load_dwordx4 v[204:207], v36, s[60:63], s75 offen nt
    s_cbranch_vccz RP_5
    s_waitcnt vmcnt(18)
RP_5:
    buffer_load_dwordx4 v[208:211], v36, s[60:63], s76 offen nt
    buffer_load_dwordx4 v[212:215], v36, s[60:63], s77 offen nt
    s_cbranch_vccz RP_6
    s_waitcnt vmcnt(18)
RP_6:
    buffer_load_dwordx4 v[216:219], v36, s[60:63], s78 offen nt
    buffer_load_dwordx4 v[220:223], v36, s[60:63], s79 offen nt
    v_add_u32 v36, s4, v36
    s_cbranch_vccz RP_7
    s_waitcnt vmcnt(18)
RP_7:
    s_waitcnt vmcnt(22)
    buffer_load_dwordx4 v[224:227], v36, s[60:63], s72 offen nt
    buffer_load_dwordx4 v[228:231], v36, s[60:63], s73 offen nt
    s_cbranch_vccz RP_8
    s_waitcnt vmcnt(18)
RP_8:
    s_waitcnt vmcnt(22)
    buffer_load_dwordx4 v[232:235], v36, s[60:63], s74 offen nt
    buffer_load_dwordx4 v[236:239], v36, s[60:63], s75 offen nt
    s_cbranch_vccz RP_9
    s_waitcnt vmcnt(18)
RP_9:
    s_waitcnt vmcnt(22)
    buffer_load_dwordx4 v[240:243], v36, s[60:63], s76 offen nt
    buffer_load_dwordx4 v[244:247], v36, s[60:63], s77 offen nt
    s_cbranch_vccz RP_10
    s_waitcnt vmcnt(18)
RP_10:
    s_waitcnt vmcnt(22)
    buffer_load_dwordx4 v[248:251], v36, s[60:63], s78 offen nt
    buffer_load_dwordx4 v[252:255], v36, s[60:63], s79 offen nt
    v_add_u32 v36, s4, v36
    s_cbranch_vccz RP_11
    s_waitcnt vmcnt(18)
RP_11:
    s_waitcnt vmcnt(22)
    s_add_u32 m0, s9, 0
    s_nop 0
    buffer_load_dwordx4 v36, s[60:63], s72 offen nt lds
    s_add_u32 m0, s9, 1024
    s_nop 0
    buffer_load_dwordx4 v36, s[60:63], s73 offen nt lds
    s_cbranch_vccz RP_12
    s_waitcnt vmcnt(18)
RP_12:
    s_waitcnt vmcnt(22)
    s_add_u32 m0, s9, 2048
    s_nop 0
    buffer_load_dwordx4 v36, s[60:63], s74 offen nt lds
    s_add_u32 m0, s9, 3072
    s_nop 0
    buffer_load_dwordx4 v36, s[60:63], s75 offen nt lds
    s_cbranch_vccz RP_13
    s_waitcnt vmcnt(18)
RP_13:
    s_waitcnt vmcnt(22)
    s_add_u32 m0, s9, 4096
    s_nop 0
    buffer_load_dwordx4 v36, s[60:63], s76 offen nt lds
    s_add_u32 m0, s9, 5120
    s_nop 0
    buffer_load_dwordx4 v36, s[60:63], s77 offen nt lds
    s_cbranch_vccz RP_14
    s_waitcnt vmcnt(18)
RP_14:
    s_waitcnt vmcnt(22)
    s_add_u32 m0, s9, 6144
    s_nop 0
    buffer_load_dwordx4 v36, s[60:63], s78 offen nt lds
    s_add_u32 m0, s9, 7168
    s_nop 0
    buffer_load_dwordx4 v36, s[60:63], s79 offen nt lds
    s_nop 1
    v_add_u32 v36, s4, v36
    s_cbranch_vccz RP_15
    s_waitcnt vmcnt(18)
RP_15:
    s_waitcnt vmcnt(22)
    s_add_u32 m0, s9, 8192
    s_nop 0
    buffer_load_dwordx4 v36, s[60:63], s72 offen nt lds
    s_add_u32 m0, s9, 9216
    s_nop 0
    buffer_load_dwordx4 v36, s[60:63], s73 offen nt lds
    s_cbranch_vccz RP_16
    s_waitcnt vmcnt(18)
RP_16:
    s_waitcnt vmcnt(22)
    s_add_u32 m0, s9, 10240
    s_nop 0
    buffer_load_dwordx4 v36, s[60:63], s74 offen nt lds
    s_add_u32 m0, s9, 11264
    s_nop 0
    buffer_load_dwordx4 v36, s[60:63], s75 offen nt lds
    s_cbranch_vccz RP_17
    s_waitcnt vmcnt(18)
RP_17:
    s_waitcnt vmcnt(22)
    s_add_u32 m0, s9, 12288
    s_nop 0
    buffer_load_dwordx4 v36, s[60:63], s76 offen nt lds
    s_add_u32 m0, s9, 13312
    s_nop 0
    buffer_load_dwordx4 v36, s[60:63], s77 offen nt lds
    s_cbranch_vccz RP_18
    s_waitcnt vmcnt(18)
RP_18:
    s_waitcnt vmcnt(22)
    s_add_u32 m0, s9, 14336
    s_nop 0
    buffer_load_dwordx4 v36, s[60:63], s78 offen nt lds
    s_add_u32 m0, s9, 15360
    s_nop 0
    buffer_load_dwordx4 v36, s[60:63], s79 offen nt lds
    s_nop 1
    v_add_u32 v36, s4, v36
    s_cbranch_vccz RP_19
    s_waitcnt vmcnt(18)
RP_19:
    s_waitcnt vmcnt(22)
    s_add_u32 m0, s9, 16384
    s_nop 0
    buffer_load_dwordx4 v36, s[60:63], s72 offen nt lds
    s_add_u32 m0, s9, 17408
    s_nop 0
    buffer_load_dwordx4 v36, s[60:63], s73 offen nt lds
    s_cbranch_vccz RP_20
    s_waitcnt vmcnt(18)
RP_20:
    s_waitcnt vmcnt(22)
    s_add_u32 m0, s9, 18432
    s_nop 0
    buffer_load_dwordx4 v36, s[60:63], s74 offen nt lds
    s_add_u32 m0, s9, 19456
    s_nop 0
    buffer_load_dwordx4 v36, s[60:63], s75 offen nt lds
    s_cbranch_vccz RP_21
    s_waitcnt vmcnt(18)
RP_21:
    s_waitcnt vmcnt(22)
    s_add_u32 m0, s9, 20480
    s_nop 0
    buffer_load_dwordx4 v36, s[60:63], s76 offen nt lds
    s_add_u32 m0, s9, 21504
    s_nop 0
    buffer_load_dwordx4 v36, s[60:63], s77 offen nt lds
    s_cbranch_vccz RP_22
    s_waitcnt vmcnt(18)
RP_22:
    s_waitcnt vmcnt(22)
    s_add_u32 m0, s9, 22528
    s_nop 0
    buffer_load_dwordx4 v36, s[60:63], s78 offen nt lds
    s_add_u32 m0, s9, 23552
    s_nop 0
    buffer_load_dwordx4 v36, s[60:63], s79 offen nt lds
    s_nop 1
    v_add_u32 v36, s4, v36
    s_cbranch_vccz RP_23
    s_waitcnt vmcnt(18)
RP_23:
    s_waitcnt vmcnt(22)
    s_add_u32 m0, s9, 24576
    s_nop 0
    buffer_load_dwordx4 v36, s[60:63], s72 offen nt lds
    s_add_u32 m0, s9, 25600
    s_nop 0
    buffer_load_dwordx4 v36, s[60:63], s73 offen nt lds
    s_cbranch_vccz RP_24
    s_waitcnt vmcnt(18)
RP_24:
    s_waitcnt vmcnt(22)
    s_add_u32 m0, s9, 26624
    s_nop 0
    buffer_load_dwordx4 v36, s[60:63], s74 offen nt lds
    s_add_u32 m0, s9, 27648
    s_nop 0
    buffer_load_dwordx4 v36, s[60:63], s75 offen nt lds
    s_cbranch_vccz RP_25
    s_waitcnt vmcnt(18)
RP_25:
    s_waitcnt vmcnt(22)
    s_add_u32 m0, s9, 28672
    s_nop 0
    buffer_load_dwordx4 v36, s[60:63], s76 offen nt lds
    s_add_u32 m0, s9, 29696
    s_nop 0
    buffer_load_dwordx4 v36, s[60:63], s77 offen nt lds
    s_cbranch_vccz RP_26
    s_waitcnt vmcnt(18)
RP_26:
    s_waitcnt vmcnt(22)
    s_add_u32 m0, s9, 30720
    s_nop 0
    buffer_load_dwordx4 v36, s[60:63], s78 offen nt lds
    s_add_u32 m0, s9, 31744
    s_nop 0
    buffer_load_dwordx4 v36, s[60:63], s79 offen nt lds
    s_nop 1
    v_add_u32 v36, s4, v36
    s_cmp_eq_u32 s42, 0
    s_cbranch_scc1 L_excl
    s_cmp_lg_u32 s3, 0
    s_cbranch_scc1 L_ready0
    v_mov_b32 v39, 0
    s_mov_b64 exec, 1
    v_mov_b32 v38, 8
    ds_add_u32 v39, v38 offset:232
    v_mov_b32 v38, 1
    ds_add_u32 v39, v38 offset:224
    s_waitcnt vmcnt(14)
    ds_add_u32 v39, v38 offset:228
    s_waitcnt vmcnt(12)
    ds_add_u32 v39, v38 offset:228
    s_waitcnt vmcnt(10)
    ds_add_u32 v39, v38 offset:228
    s_waitcnt vmcnt(8)
    ds_add_u32 v39, v38 offset:228
    s_waitcnt vmcnt(6)
    ds_add_u32 v39, v38 offset:228
    s_waitcnt vmcnt(4)
    ds_add_u32 v39, v38 offset:228
    s_waitcnt vmcnt(2)
    ds_add_u32 v39, v38 offset:228
    s_waitcnt vmcnt(0)
    ds_add_u32 v39, v38 offset:228
    s_mov_b64 exec, -1
L_ready0:
    s_load_dword s46, s[34:35], 0
    s_load_dword s26, s[44:45], 327680
    s_waitcnt lgkmcnt(0)
    s_mul_i32 s26, s26, 0x9e3779b1
    s_add_u32 s26, s26, 0x7f4a7c15
    s_branch L_ready
L_excl:
    v_mov_b32 v39, 0
    s_mov_b64 exec, 1
    v_mov_b32 v38, 0
    ds_add_u32 v39, v38 offset:232
    v_mov_b32 v38, 1
    ds_add_u32 v39, v38 offset:224
    s_mov_b64 exec, -1
L_ready:
    v_mov_b32 v39, 0
    s_waitcnt vmcnt(0)
    s_mov_b64 exec, 1
    v_mov_b32 v38, 1
    ds_add_u32 v39, v38 offset:36
    s_mov_b64 exec, -1
    s_lshl_b32 s8, s3, 11
    v_mov_b32 v39, 0
LW_27:
    ds_read_b32 v38, v39 offset:40
    s_waitcnt lgkmcnt(0)
    v_readfirstlane_b32 s7, v38
    s_cmp_ge_u32 s7, 2
    s_cbranch_scc1 LWD_28
    s_sleep 1
    s_sub_u32 s10, s10, 1
    s_cbranch_scc0 LW_27
    s_mov_b32 s10, 0
LWD_28:
    s_nop 4
L_gemv:
    v_lshrrev_b32 v40, 5, v1
    v_and_b32 v42, 1, v3
    v_lshlrev_b32 v42, 10, v42
    v_bfe_u32 v43, v3, 1, 1
    v_lshl_add_u32 v42, v43, 6, v42
    v_lshl_add_u32 v42, v2, 4, v42
    v_add_u32 v42, s8, v42
    ds_read_b128 v[4:7], v42 offset:8192
    ds_read_b128 v[8:11], v42 offset:8320
    ds_read_b128 v[12:15], v42 offset:8448
    ds_read_b128 v[16:19], v42 offset:8576
    v_perm_b32 v96, v132, v128, s11
    v_perm_b32 v97, v140, v136, s11
    v_perm_b32 v98, v148, v144, s11
    v_perm_b32 v99, v156, v152, s11
    v_perm_b32 v100, v132, v128, s12
    v_perm_b32 v101, v140, v136, s12
    v_perm_b32 v102, v148, v144, s12
    v_perm_b32 v103, v156, v152, s12
    s_waitcnt lgkmcnt(0)
    v_mfma_f32_16x16x32_bf16 v[64:67], v[4:7], v[96:99], 0
    v_perm_b32 v104, v133, v129, s11
    v_perm_b32 v105, v141, v137, s11
    v_perm_b32 v106, v149, v145, s11
    v_perm_b32 v107, v157, v153, s11
    v_mfma_f32_16x16x32_bf16 v[68:71], v[4:7], v[100:103], 0
    v_perm_b32 v108, v133, v129, s12
    v_perm_b32 v109, v141, v137, s12
    v_perm_b32 v110, v149, v145, s12
    v_perm_b32 v111, v157, v153, s12
    v_mfma_f32_16x16x32_bf16 v[72:75], v[4:7], v[104:107], 0
    v_perm_b32 v96, v134, v130, s11
    v_perm_b32 v97, v142, v138, s11
    v_perm_b32 v98, v150, v146, s11
    v_perm_b32 v99, v158, v154, s11
    v_mfma_f32_16x16x32_bf16 v[76:79], v[4:7], v[108:111], 0
    v_perm_b32 v100, v134, v130, s12
    v_perm_b32 v101, v142, v138, s12
    v_perm_b32 v102, v150, v146, s12
    v_perm_b32 v103, v158, v154, s12
    v_mfma_f32_16x16x32_bf16 v[80:83], v[4:7], v[96:99], 0
    v_perm_b32 v104, v135, v131, s11
    v_perm_b32 v105, v143, v139, s11
    v_perm_b32 v106, v151, v147, s11
    v_perm_b32 v107, v159, v155, s11
    v_mfma_f32_16x16x32_bf16 v[84:87], v[4:7], v[100:103], 0
    v_perm_b32 v108, v135, v131, s12
    v_perm_b32 v109, v143, v139, s12
    v_perm_b32 v110, v151, v147, s12
    v_perm_b32 v111, v159, v155, s12
    v_mfma_f32_16x16x32_bf16 v[88:91], v[4:7], v[104:107], 0
    v_perm_b32 v96, v164, v160, s11
    v_perm_b32 v97, v172, v168, s11
    v_perm_b32 v98, v180, v176, s11
    v_perm_b32 v99, v188, v184, s11
    v_mfma_f32_16x16x32_bf16 v[92:95], v[4:7], v[108:111], 0
    v_perm_b32 v100, v164, v160, s12
    v_perm_b32 v101, v172, v168, s12
    v_perm_b32 v102, v180, v176, s12
    v_perm_b32 v103, v188, v184, s12
    v_mfma_f32_16x16x32_bf16 v[64:67], v[8:11], v[96:99], v[64:67]
    v_perm_b32 v104, v165, v161, s11
    v_perm_b32 v105, v173, v169, s11
    v_perm_b32 v106, v181, v177, s11
    v_perm_b32 v107, v189, v185, s11
    v_mfma_f32_16x16x32_bf16 v[68:71], v[8:11], v[100:103], v[68:71]
    v_perm_b32 v108, v165, v161, s12
    v_perm_b32 v109, v173, v169, s12
    v_perm_b32 v110, v181, v177, s12
    v_perm_b32 v111, v189, v185, s12
    v_mfma_f32_16x16x32_bf16 v[72:75], v[8:11], v[104:107], v[72:75]
    v_perm_b32 v96, v166, v162, s11
    v_perm_b32 v97, v174, v170, s11
    v_perm_b32 v98, v182, v178, s11
    v_perm_b32 v99, v190, v186, s11
    v_mfma_f32_16x16x32_bf16 v[76:79], v[8:11], v[108:111], v[76:79]
    v_perm_b32 v100, v166, v162, s12
    v_perm_b32 v101, v174, v170, s12
    v_perm_b32 v102, v182, v178, s12
    v_perm_b32 v103, v190, v186, s12
    v_mfma_f32_16x16x32_bf16 v[80:83], v[8:11], v[96:99], v[80:83]
    v_perm_b32 v104, v167, v163, s11
    v_perm_b32 v105, v175, v171, s11
    v_perm_b32 v106, v183, v179, s11
    v_perm_b32 v107, v191, v187, s11
    v_mfma_f32_16x16x32_bf16 v[84:87], v[8:11], v[100:103], v[84:87]
    v_perm_b32 v108, v167, v163, s12
    v_perm_b32 v109, v175, v171, s12
    v_perm_b32 v110, v183, v179, s12
    v_perm_b32 v111, v191, v187, s12
    v_mfma_f32_16x16x32_bf16 v[88:91], v[8:11], v[104:107], v[88:91]
    v_perm_b32 v96, v196, v192, s11
    v_perm_b32 v97, v204, v200, s11
    v_perm_b32 v98, v212, v208, s11
    v_perm_b32 v99, v220, v216, s11
    v_mfma_f32_16x16x32_bf16 v[92:95], v[8:11], v[108:111], v[92:95]
    v_perm_b32 v100, v196, v192, s12
    v_perm_b32 v101, v204, v200, s12
    v_perm_b32 v102, v212, v208, s12
    v_perm_b32 v103, v220, v216, s12
    v_mfma_f32_16x16x32_bf16 v[64:67], v[12:15], v[96:99], v[64:67]
    v_perm_b32 v104, v197, v193, s11
    v_perm_b32 v105, v205, v201, s11
    v_perm_b32 v106, v213, v209, s11
    v_perm_b32 v107, v221, v217, s11
    v_mfma_f32_16x16x32_bf16 v[68:71], v[12:15], v[100:103], v[68:71]
    v_perm_b32 v108, v197, v193, s12
    v_perm_b32 v109, v205, v201, s12
    v_perm_b32 v110, v213, v209, s12
    v_perm_b32 v111, v221, v217, s12
    v_mfma_f32_16x16x32_bf16 v[72:75], v[12:15], v[104:107], v[72:75]
    v_perm_b32 v96, v198, v194, s11
    v_perm_b32 v97, v206, v202, s11
    v_perm_b32 v98, v214, v210, s11
    v_perm_b32 v99, v222, v218, s11
    v_mfma_f32_16x16x32_bf16 v[76:79], v[12:15], v[108:111], v[76:79]
    v_perm_b32 v100, v198, v194, s12
    v_perm_b32 v101, v206, v202, s12
    v_perm_b32 v102, v214, v210, s12
    v_perm_b32 v103, v222, v218, s12
    v_mfma_f32_16x16x32_bf16 v[80:83], v[12:15], v[96:99], v[80:83]
    v_perm_b32 v104, v199, v195, s11
    v_perm_b32 v105, v207, v203, s11
    v_perm_b32 v106, v215, v211, s11
    v_perm_b32 v107, v223, v219, s11
    v_mfma_f32_16x16x32_bf16 v[84:87], v[12:15], v[100:103], v[84:87]
    v_perm_b32 v108, v199, v195, s12
    v_perm_b32 v109, v207, v203, s12
    v_perm_b32 v110, v215, v211, s12
    v_perm_b32 v111, v223, v219, s12
    v_mfma_f32_16x16x32_bf16 v[88:91], v[12:15], v[104:107], v[88:91]
    v_perm_b32 v96, v228, v224, s11
    v_perm_b32 v97, v236, v232, s11
    v_perm_b32 v98, v244, v240, s11
    v_perm_b32 v99, v252, v248, s11
    v_mfma_f32_16x16x32_bf16 v[92:95], v[12:15], v[108:111], v[92:95]
    v_perm_b32 v100, v228, v224, s12
    v_perm_b32 v101, v236, v232, s12
    v_perm_b32 v102, v244, v240, s12
    v_perm_b32 v103, v252, v248, s12
    v_mfma_f32_16x16x32_bf16 v[64:67], v[16:19], v[96:99], v[64:67]
    v_perm_b32 v104, v229, v225, s11
    v_perm_b32 v105, v237, v233, s11
    v_perm_b32 v106, v245, v241, s11
    v_perm_b32 v107, v253, v249, s11
    v_mfma_f32_16x16x32_bf16 v[68:71], v[16:19], v[100:103], v[68:71]
    v_perm_b32 v108, v229, v225, s12
    v_perm_b32 v109, v237, v233, s12
    v_perm_b32 v110, v245, v241, s12
    v_perm_b32 v111, v253, v249, s12
    v_mfma_f32_16x16x32_bf16 v[72:75], v[16:19], v[104:107], v[72:75]
    v_perm_b32 v96, v230, v226, s11
    v_perm_b32 v97, v238, v234, s11
    v_perm_b32 v98, v246, v242, s11
    v_perm_b32 v99, v254, v250, s11
    v_mfma_f32_16x16x32_bf16 v[76:79], v[16:19], v[108:111], v[76:79]
    v_perm_b32 v100, v230, v226, s12
    v_perm_b32 v101, v238, v234, s12
    v_perm_b32 v102, v246, v242, s12
    v_perm_b32 v103, v254, v250, s12
    v_mfma_f32_16x16x32_bf16 v[80:83], v[16:19], v[96:99], v[80:83]
    v_perm_b32 v104, v231, v227, s11
    v_perm_b32 v105, v239, v235, s11
    v_perm_b32 v106, v247, v243, s11
    v_perm_b32 v107, v255, v251, s11
    v_mfma_f32_16x16x32_bf16 v[84:87], v[16:19], v[100:103], v[84:87]
    v_perm_b32 v108, v231, v227, s12
    v_perm_b32 v109, v239, v235, s12
    v_perm_b32 v110, v247, v243, s12
    v_perm_b32 v111, v255, v251, s12
    v_mfma_f32_16x16x32_bf16 v[88:91], v[16:19], v[104:107], v[88:91]
    s_nop 0
    v_mfma_f32_16x16x32_bf16 v[92:95], v[16:19], v[108:111], v[92:95]
    v_add_f32_dpp v44, v66, v64 row_ror:8 row_mask:0xf bank_mask:0xf
    v_add_f32_dpp v45, v70, v68 row_ror:8 row_mask:0xf bank_mask:0xf
    v_add_f32_dpp v46, v74, v72 row_ror:8 row_mask:0xf bank_mask:0xf
    v_add_f32_dpp v47, v78, v76 row_ror:8 row_mask:0xf bank_mask:0xf
    v_add_f32_dpp v48, v82, v80 row_ror:8 row_mask:0xf bank_mask:0xf
    v_add_f32_dpp v49, v86, v84 row_ror:8 row_mask:0xf bank_mask:0xf
    v_add_f32_dpp v50, v90, v88 row_ror:8 row_mask:0xf bank_mask:0xf
    s_nop 0
    v_add_f32_dpp v51, v94, v92 row_ror:8 row_mask:0xf bank_mask:0xf
    v_add_f32_dpp v52, v67, v65 row_ror:8 row_mask:0xf bank_mask:0xf
    v_add_f32_dpp v53, v71, v69 row_ror:8 row_mask:0xf bank_mask:0xf
    v_add_f32_dpp v54, v75, v73 row_ror:8 row_mask:0xf bank_mask:0xf
    v_add_f32_dpp v55, v79, v77 row_ror:8 row_mask:0xf bank_mask:0xf
    v_add_f32_dpp v56, v83, v81 row_ror:8 row_mask:0xf bank_mask:0xf
    v_add_f32_dpp v57, v87, v85 row_ror:8 row_mask:0xf bank_mask:0xf
    v_add_f32_dpp v58, v91, v89 row_ror:8 row_mask:0xf bank_mask:0xf
    v_add_f32_dpp v59, v95, v93 row_ror:8 row_mask:0xf bank_mask:0xf
    v_cndmask_b32 v64, v44, v48, s[68:69]
    v_cndmask_b32 v65, v52, v56, s[68:69]
    v_cndmask_b32 v60, v64, v65, s[70:71]
    v_cndmask_b32 v64, v45, v49, s[68:69]
    v_cndmask_b32 v65, v53, v57, s[68:69]
    v_cndmask_b32 v61, v64, v65, s[70:71]
    v_cndmask_b32 v64, v46, v50, s[68:69]
    v_cndmask_b32 v65, v54, v58, s[68:69]
    v_cndmask_b32 v62, v64, v65, s[70:71]
    v_cndmask_b32 v64, v47, v51, s[68:69]
    v_cndmask_b32 v65, v55, v59, s[68:69]
    v_cndmask_b32 v63, v64, v65, s[70:71]
    s_and_b32 s7, s3, 3
    s_lshl_b32 s7, s7, 9
    v_lshl_add_u32 v42, v40, 8, s7
    v_and_b32 v43, 1, v2
    v_lshl_add_u32 v42, v43, 4, v42
    v_lshl_add_u32 v42, v3, 5, v42
    s_mov_b32 exec_lo, 0x00ff00ff
    s_mov_b32 exec_hi, 0x00ff00ff
    ds_write_b128 v42, v[60:63] offset:12288
    s_mov_b64 exec, -1
    s_cmp_eq_u32 s3, 0
    s_cbranch_scc1 L_w0fin
    v_mov_b32 v65, 0
    s_mov_b64 exec, 1
    v_mov_b32 v64, 1
    ds_add_u32 v65, v64 offset:16
    s_mov_b64 exec, -1
    s_cmp_eq_u32 s3, 1
    s_cbranch_scc1 L_helper
    s_lshr_b32 s8, s6, 3
    s_cmp_eq_u32 s8, 2
    s_cbranch_scc1 L_stream
    s_branch L_tab
L_w0fin:
    v_mov_b32 v77, s26
    v_mov_b32 v79, s26
    v_mul_u32_u24 v44, 40960, v2
    v_lshl_add_u32 v44, v3, 4, v44
    v_lshlrev_b32 v42, 4, v1
    v_mul_u32_u24 v43, 1280, v1
    s_bfe_u32 s72, s27, 0x10003
    s_mul_i32 s72, s72, 10240
    s_lshr_b32 s8, s27, 4
    s_lshl_b32 s8, s8, 3
    s_and_b32 s9, s27, 7
    s_add_u32 s8, s8, s9
    s_lshl_b32 s8, s8, 2
    s_add_u32 s72, s72, s8
    s_add_u32 s72, s72, 851968
    s_sub_u32 s8, s27, 96
    s_lshr_b32 s9, s8, 4
    s_mul_i32 s9, s9, 10240
    s_and_b32 s8, s8, 15
    s_lshl_b32 s8, s8, 2
    s_add_u32 s8, s8, s9
    s_add_u32 s8, s8, 872448
    s_cmp_lt_u32 s2, 32
    s_cselect_b32 s8, s72, s8
    s_lshl_b32 s9, s27, 8
    v_mov_b32 v65, 0
LW_29:
    ds_read_b32 v64, v65 offset:16
    s_waitcnt lgkmcnt(0)
    v_readfirstlane_b32 s7, v64
    s_cmp_ge_u32 s7, 3
    s_cbranch_scc1 LWD_30
    s_sleep 1
    s_sub_u32 s10, s10, 1
    s_cbranch_scc0 LW_29
    s_mov_b32 s10, 0
LWD_30:
    s_nop 4
    ds_read_b128 v[60:63], v42 offset:12288
    ds_read_b128 v[64:67], v42 offset:12800
    ds_read_b128 v[68:71], v42 offset:13312
    ds_read_b128 v[72:75], v42 offset:13824
    s_waitcnt lgkmcnt(0)
    v_pk_add_f32 v[60:61], v[60:61], v[68:69]
    v_pk_add_f32 v[62:63], v[62:63], v[70:71]
    v_pk_add_f32 v[64:65], v[64:65], v[72:73]
    v_pk_add_f32 v[66:67], v[66:67], v[74:75]
    v_pk_add_f32 v[60:61], v[60:61], v[64:65]
    v_pk_add_f32 v[62:63], v[62:63], v[66:67]
    v_cvt_pk_bf16_f32 v76, v60, v61
    v_cvt_pk_bf16_f32 v78, v62, v63
    s_mov_b32 exec_hi, 0
    buffer_store_dwordx4 v[76:79], v44, s[56:59], s9 offen sc1
    s_mov_b64 exec, 0xff
    s_cmp_ge_u32 s2, 192
    s_cbranch_scc1 L_nogate
    s_add_u32 s72, s44, s8
    s_addc_u32 s73, s45, 0
    s_atomic_swap s26, s[72:73], 0
    s_atomic_swap s26, s[72:73], 1280
    s_atomic_swap s26, s[72:73], 2560
    s_atomic_swap s26, s[72:73], 3840
    s_atomic_swap s26, s[72:73], 5120
    s_atomic_swap s26, s[72:73], 6400
    s_atomic_swap s26, s[72:73], 7680
    s_atomic_swap s26, s[72:73], 8960
L_nogate:
    s_mov_b64 exec, -1
    s_branch L_helper
L_norole:
    s_branch L_helper
L_w45:
    s_or_b32 s7, s1, s42
    s_cbranch_scc0 L_tab
    s_setprio 3
    s_and_b32 s47, s3, 1
    s_lshr_b32 s8, s6, 3
    s_cmp_eq_u32 s8, 2
    s_cselect_b32 s64, s16, s36
    s_cselect_b32 s65, s17, s37
    s_mov_b32 s66, 4096
    s_mov_b32 s67, 0x20000
    v_lshrrev_b32 v40, 5, v1
    v_and_b32 v41, 31, v1
    v_lshlrev_b32 v42, 11, v40
    v_lshl_add_u32 v42, v41, 3, v42
    s_lshl_b32 s7, s47, 10
    v_lshlrev_b32 v43, 6, v1
    buffer_load_dwordx2 v[44:45], v42, s[64:67], s7 offen offset:0
    buffer_load_dwordx2 v[46:47], v42, s[64:67], s7 offen offset:256
    buffer_load_dwordx2 v[48:49], v42, s[64:67], s7 offen offset:512
    buffer_load_dwordx2 v[50:51], v42, s[64:67], s7 offen offset:768
    s_cmp_lg_u32 s8, 2
    s_cbranch_scc1 L_norow
    v_lshl_add_u32 v43, v41, 3, v42
    buffer_load_dwordx4 v[84:87], v43, s[64:67], 0 offen offset:0
    buffer_load_dwordx4 v[88:91], v43, s[64:67], 0 offen offset:512
    buffer_load_dwordx4 v[92:95], v43, s[64:67], 0 offen offset:1024
    buffer_load_dwordx4 v[96:99], v43, s[64:67], 0 offen offset:1536
L_norow:
    s_load_dword s46, s[34:35], 0
    s_load_dword s26, s[44:45], 327680
    s_waitcnt lgkmcnt(0)
    s_mul_i32 s26, s26, 0x9e3779b1
    s_add_u32 s26, s26, 0x7f4a7c15
    s_waitcnt vmcnt(0)
    v_lshlrev_b32 v52, 16, v44
    v_and_b32 v53, 0xffff0000, v44
    v_lshlrev_b32 v54, 16, v45
    v_and_b32 v55, 0xffff0000, v45
    v_lshlrev_b32 v56, 16, v46
    v_and_b32 v57, 0xffff0000, v46
    v_lshlrev_b32 v58, 16, v47
    v_and_b32 v59, 0xffff0000, v47
    v_lshlrev_b32 v60, 16, v48
    v_and_b32 v61, 0xffff0000, v48
    v_lshlrev_b32 v62, 16, v49
    v_and_b32 v63, 0xffff0000, v49
    v_lshlrev_b32 v64, 16, v50
    v_and_b32 v65, 0xffff0000, v50
    v_lshlrev_b32 v66, 16, v51
    v_and_b32 v67, 0xffff0000, v51
    s_cmp_eq_u32 s8, 2
    s_cbranch_scc1 L_hop_a
    v_mul_f32 v68, s14, v52
    v_mul_f32 v69, s14, v53
    v_mul_f32 v70, s14, v54
    v_mul_f32 v71, s14, v55
    v_mul_f32 v72, s14, v56
    v_mul_f32 v73, s14, v57
    v_mul_f32 v74, s14, v58
    v_mul_f32 v75, s14, v59
    v_mul_f32 v76, s14, v60
    v_mul_f32 v77, s14, v61
    v_mul_f32 v78, s14, v62
    v_mul_f32 v79, s14, v63
    v_mul_f32 v80, s14, v64
    v_mul_f32 v81, s14, v65
    v_mul_f32 v82, s14, v66
    v_mul_f32 v83, s14, v67
    v_exp_f32 v68, -v68
    v_exp_f32 v69, -v69
    v_exp_f32 v70, -v70
    v_exp_f32 v71, -v71
    v_exp_f32 v72, -v72
    v_exp_f32 v73, -v73
    v_exp_f32 v74, -v74
    v_exp_f32 v75, -v75
    v_exp_f32 v76, -v76
    v_exp_f32 v77, -v77
    v_exp_f32 v78, -v78
    v_exp_f32 v79, -v79
    v_exp_f32 v80, -v80
    v_exp_f32 v81, -v81
    v_exp_f32 v82, -v82
    v_exp_f32 v83, -v83
    v_add_f32 v68, 1.0, v68
    v_add_f32 v69, 1.0, v69
    v_add_f32 v70, 1.0, v70
    v_add_f32 v71, 1.0, v71
    v_add_f32 v72, 1.0, v72
    v_add_f32 v73, 1.0, v73
    v_add_f32 v74, 1.0, v74
    v_add_f32 v75, 1.0, v75
    v_add_f32 v76, 1.0, v76
    v_add_f32 v77, 1.0, v77
    v_add_f32 v78, 1.0, v78
    v_add_f32 v79, 1.0, v79
    v_add_f32 v80, 1.0, v80
    v_add_f32 v81, 1.0, v81
    v_add_f32 v82, 1.0, v82
    v_add_f32 v83, 1.0, v83
    v_rcp_f32 v68, v68
    v_rcp_f32 v69, v69
    v_rcp_f32 v70, v70
    v_rcp_f32 v71, v71
    v_rcp_f32 v72, v72
    v_rcp_f32 v73, v73
    v_rcp_f32 v74, v74
    v_rcp_f32 v75, v75
    v_rcp_f32 v76, v76
    v_rcp_f32 v77, v77
    v_rcp_f32 v78, v78
    v_rcp_f32 v79, v79
    v_rcp_f32 v80, v80
    v_rcp_f32 v81, v81
    v_rcp_f32 v82, v82
    v_rcp_f32 v83, v83
    v_mul_f32 v52, v52, v68
    v_mul_f32 v53, v53, v69
    v_mul_f32 v54, v54, v70
    v_mul_f32 v55, v55, v71
    v_mul_f32 v56, v56, v72
    v_mul_f32 v57, v57, v73
    v_mul_f32 v58, v58, v74
    v_mul_f32 v59, v59, v75
    v_mul_f32 v60, v60, v76
    v_mul_f32 v61, v61, v77
    v_mul_f32 v62, v62, v78
    v_mul_f32 v63, v63, v79
    v_mul_f32 v64, v64, v80
    v_mul_f32 v65, v65, v81
    v_mul_f32 v66, v66, v82
    v_mul_f32 v67, v67, v83
    s_nop 0
    s_branch L_act
L_hop_a:
    v_lshlrev_b32 v4, 16, v84
    v_and_b32 v5, 0xffff0000, v84
    v_lshlrev_b32 v6, 16, v85
    v_and_b32 v7, 0xffff0000, v85
    v_lshlrev_b32 v8, 16, v86
    v_and_b32 v9, 0xffff0000, v86
    v_lshlrev_b32 v10, 16, v87
    v_and_b32 v11, 0xffff0000, v87
    v_lshlrev_b32 v12, 16, v88
    v_and_b32 v13, 0xffff0000, v88
    v_lshlrev_b32 v14, 16, v89
    v_and_b32 v15, 0xffff0000, v89
    v_lshlrev_b32 v16, 16, v90
    v_and_b32 v17, 0xffff0000, v90
    v_lshlrev_b32 v18, 16, v91
    v_and_b32 v19, 0xffff0000, v91
    v_lshlrev_b32 v20, 16, v92
    v_and_b32 v21, 0xffff0000, v92
    v_lshlrev_b32 v22, 16, v93
    v_and_b32 v23, 0xffff0000, v93
    v_lshlrev_b32 v24, 16, v94
    v_and_b32 v25, 0xffff0000, v94
    v_lshlrev_b32 v26, 16, v95
    v_and_b32 v27, 0xffff0000, v95
    v_lshlrev_b32 v28, 16, v96
    v_and_b32 v29, 0xffff0000, v96
    v_lshlrev_b32 v30, 16, v97
    v_and_b32 v31, 0xffff0000, v97
    v_lshlrev_b32 v32, 16, v98
    v_and_b32 v33, 0xffff0000, v98
    v_lshlrev_b32 v34, 16, v99
    v_and_b32 v35, 0xffff0000, v99
    v_add_f32 v104, v4, v5
    v_add_f32 v104, v104, v6
    v_add_f32 v104, v104, v7
    v_add_f32 v104, v104, v8
    v_add_f32 v104, v104, v9
    v_add_f32 v104, v104, v10
    v_add_f32 v104, v104, v11
    v_add_f32 v104, v104, v12
    v_add_f32 v104, v104, v13
    v_add_f32 v104, v104, v14
    v_add_f32 v104, v104, v15
    v_add_f32 v104, v104, v16
    v_add_f32 v104, v104, v17
    v_add_f32 v104, v104, v18
    v_add_f32 v104, v104, v19
    v_add_f32 v104, v104, v20
    v_add_f32 v104, v104, v21
    v_add_f32 v104, v104, v22
    v_add_f32 v104, v104, v23
    v_add_f32 v104, v104, v24
    v_add_f32 v104, v104, v25
    v_add_f32 v104, v104, v26
    v_add_f32 v104, v104, v27
    v_add_f32 v104, v104, v28
    v_add_f32 v104, v104, v29
    v_add_f32 v104, v104, v30
    v_add_f32 v104, v104, v31
    v_add_f32 v104, v104, v32
    v_add_f32 v104, v104, v33
    v_add_f32 v104, v104, v34
    v_add_f32 v104, v104, v35
    s_nop 1
    v_add_f32_dpp v104, v104, v104 row_ror:8 row_mask:0xf bank_mask:0xf
    s_nop 1
    v_add_f32_dpp v104, v104, v104 row_ror:4 row_mask:0xf bank_mask:0xf
    s_nop 1
    v_add_f32_dpp v104, v104, v104 row_ror:2 row_mask:0xf bank_mask:0xf
    s_nop 1
    v_add_f32_dpp v104, v104, v104 row_ror:1 row_mask:0xf bank_mask:0xf
    v_mov_b32 v105, v104
    s_nop 1
    v_permlane16_swap_b32 v104, v105
    v_add_f32 v104, v104, v105
    v_mul_f32 v104, 0x3a800000, v104
    v_mov_b32 v106, 0
    v_sub_f32 v105, v4, v104
    v_fmac_f32 v106, v105, v105
    v_sub_f32 v105, v5, v104
    v_fmac_f32 v106, v105, v105
    v_sub_f32 v105, v6, v104
    v_fmac_f32 v106, v105, v105
    v_sub_f32 v105, v7, v104
    v_fmac_f32 v106, v105, v105
    v_sub_f32 v105, v8, v104
    v_fmac_f32 v106, v105, v105
    v_sub_f32 v105, v9, v104
    v_fmac_f32 v106, v105, v105
    v_sub_f32 v105, v10, v104
    v_fmac_f32 v106, v105, v105
    v_sub_f32 v105, v11, v104
    v_fmac_f32 v106, v105, v105
    v_sub_f32 v105, v12, v104
    v_fmac_f32 v106, v105, v105
    v_sub_f32 v105, v13, v104
    v_fmac_f32 v106, v105, v105
    v_sub_f32 v105, v14, v104
    v_fmac_f32 v106, v105, v105
    v_sub_f32 v105, v15, v104
    v_fmac_f32 v106, v105, v105
    v_sub_f32 v105, v16, v104
    v_fmac_f32 v106, v105, v105
    v_sub_f32 v105, v17, v104
    v_fmac_f32 v106, v105, v105
    v_sub_f32 v105, v18, v104
    v_fmac_f32 v106, v105, v105
    v_sub_f32 v105, v19, v104
    v_fmac_f32 v106, v105, v105
    v_sub_f32 v105, v20, v104
    v_fmac_f32 v106, v105, v105
    v_sub_f32 v105, v21, v104
    v_fmac_f32 v106, v105, v105
    v_sub_f32 v105, v22, v104
    v_fmac_f32 v106, v105, v105
    v_sub_f32 v105, v23, v104
    v_fmac_f32 v106, v105, v105
    v_sub_f32 v105, v24, v104
    v_fmac_f32 v106, v105, v105
    v_sub_f32 v105, v25, v104
    v_fmac_f32 v106, v105, v105
    v_sub_f32 v105, v26, v104
    v_fmac_f32 v106, v105, v105
    v_sub_f32 v105, v27, v104
    v_fmac_f32 v106, v105, v105
    v_sub_f32 v105, v28, v104
    v_fmac_f32 v106, v105, v105
    v_sub_f32 v105, v29, v104
    v_fmac_f32 v106, v105, v105
    v_sub_f32 v105, v30, v104
    v_fmac_f32 v106, v105, v105
    v_sub_f32 v105, v31, v104
    v_fmac_f32 v106, v105, v105
    v_sub_f32 v105, v32, v104
    v_fmac_f32 v106, v105, v105
    v_sub_f32 v105, v33, v104
    v_fmac_f32 v106, v105, v105
    v_sub_f32 v105, v34, v104
    v_fmac_f32 v106, v105, v105
    v_sub_f32 v105, v35, v104
    v_fmac_f32 v106, v105, v105
    s_nop 1
    v_add_f32_dpp v106, v106, v106 row_ror:8 row_mask:0xf bank_mask:0xf
    s_nop 1
    v_add_f32_dpp v106, v106, v106 row_ror:4 row_mask:0xf bank_mask:0xf
    s_nop 1
    v_add_f32_dpp v106, v106, v106 row_ror:2 row_mask:0xf bank_mask:0xf
    s_nop 1
    v_add_f32_dpp v106, v106, v106 row_ror:1 row_mask:0xf bank_mask:0xf
    v_mov_b32 v105, v106
    s_nop 1
    v_permlane16_swap_b32 v106, v105
    v_add_f32 v106, v106, v105
    v_mul_f32 v106, 0x3a800000, v106
    v_cvt_pk_bf16_f32 v104, 0, v104
    v_cvt_pk_bf16_f32 v106, 0, v106
    v_add_f32 v106, 0x3727c5ac, v106
    v_cvt_pk_bf16_f32 v106, 0, v106
    v_sqrt_f32 v106, v106
    s_nop 0
    v_cvt_pk_bf16_f32 v106, 0, v106
    v_rcp_f32 v106, v106
    v_sub_f32 v52, v52, v104
    v_sub_f32 v53, v53, v104
    v_sub_f32 v54, v54, v104
    v_sub_f32 v55, v55, v104
    v_sub_f32 v56, v56, v104
    v_sub_f32 v57, v57, v104
    v_sub_f32 v58, v58, v104
    v_sub_f32 v59, v59, v104
    v_sub_f32 v60, v60, v104
    v_sub_f32 v61, v61, v104
    v_sub_f32 v62, v62, v104
    v_sub_f32 v63, v63, v104
    v_sub_f32 v64, v64, v104
    v_sub_f32 v65, v65, v104
    v_sub_f32 v66, v66, v104
    v_sub_f32 v67, v67, v104
    v_cvt_pk_bf16_f32 v52, 0, v52
    v_cvt_pk_bf16_f32 v53, 0, v53
    v_cvt_pk_bf16_f32 v54, 0, v54
    v_cvt_pk_bf16_f32 v55, 0, v55
    v_cvt_pk_bf16_f32 v56, 0, v56
    v_cvt_pk_bf16_f32 v57, 0, v57
    v_cvt_pk_bf16_f32 v58, 0, v58
    v_cvt_pk_bf16_f32 v59, 0, v59
    v_cvt_pk_bf16_f32 v60, 0, v60
    v_cvt_pk_bf16_f32 v61, 0, v61
    v_cvt_pk_bf16_f32 v62, 0, v62
    v_cvt_pk_bf16_f32 v63, 0, v63
    v_cvt_pk_bf16_f32 v64, 0, v64
    v_cvt_pk_bf16_f32 v65, 0, v65
    v_cvt_pk_bf16_f32 v66, 0, v66
    v_cvt_pk_bf16_f32 v67, 0, v67
    v_mul_f32 v52, v52, v106
    v_mul_f32 v53, v53, v106
    v_mul_f32 v54, v54, v106
    v_mul_f32 v55, v55, v106
    v_mul_f32 v56, v56, v106
    v_mul_f32 v57, v57, v106
    v_mul_f32 v58, v58, v106
    v_mul_f32 v59, v59, v106
    v_mul_f32 v60, v60, v106
    v_mul_f32 v61, v61, v106
    v_mul_f32 v62, v62, v106
    v_mul_f32 v63, v63, v106
    v_mul_f32 v64, v64, v106
    v_mul_f32 v65, v65, v106
    v_mul_f32 v66, v66, v106
    v_mul_f32 v67, v67, v106
    v_cvt_pk_bf16_f32 v52, 0, v52
    v_cvt_pk_bf16_f32 v53, 0, v53
    v_cvt_pk_bf16_f32 v54, 0, v54
    v_cvt_pk_bf16_f32 v55, 0, v55
    v_cvt_pk_bf16_f32 v56, 0, v56
    v_cvt_pk_bf16_f32 v57, 0, v57
    v_cvt_pk_bf16_f32 v58, 0, v58
    v_cvt_pk_bf16_f32 v59, 0, v59
    v_cvt_pk_bf16_f32 v60, 0, v60
    v_cvt_pk_bf16_f32 v61, 0, v61
    v_cvt_pk_bf16_f32 v62, 0, v62
    v_cvt_pk_bf16_f32 v63, 0, v63
    v_cvt_pk_bf16_f32 v64, 0, v64
    v_cvt_pk_bf16_f32 v65, 0, v65
    v_cvt_pk_bf16_f32 v66, 0, v66
    v_cvt_pk_bf16_f32 v67, 0, v67
    v_mul_u32_u24 v42, 40960, v40
    v_lshl_add_u32 v42, v41, 4, v42
    s_lshl_b32 s8, s47, 11
    s_add_u32 s9, s8, 4096
    s_and_b32 s7, s6, 7
    s_lshl_b32 s72, s47, 3
    s_add_u32 s7, s7, s72
    s_mul_i32 s7, s7, 1280
    s_add_u32 s7, s7, 851968
GT_31:
    s_load_dwordx16 s[72:87], s[44:45], s7 glc
    s_waitcnt lgkmcnt(0)
    s_xor_b32 s72, s72, s26
    s_xor_b32 s73, s73, s26
    s_xor_b32 s74, s74, s26
    s_xor_b32 s75, s75, s26
    s_xor_b32 s76, s76, s26
    s_xor_b32 s77, s77, s26
    s_xor_b32 s78, s78, s26
    s_xor_b32 s79, s79, s26
    s_xor_b32 s80, s80, s26
    s_xor_b32 s81, s81, s26
    s_xor_b32 s82, s82, s26
    s_xor_b32 s83, s83, s26
    s_xor_b32 s84, s84, s26
    s_xor_b32 s85, s85, s26
    s_xor_b32 s86, s86, s26
    s_xor_b32 s87, s87, s26
    s_or_b64 s[72:73], s[72:73], s[74:75]
    s_or_b64 s[72:73], s[72:73], s[76:77]
    s_or_b64 s[72:73], s[72:73], s[78:79]
    s_or_b64 s[72:73], s[72:73], s[80:81]
    s_or_b64 s[72:73], s[72:73], s[82:83]
    s_or_b64 s[72:73], s[72:73], s[84:85]
    s_or_b64 s[72:73], s[72:73], s[86:87]
    s_cbranch_scc0 GTD_32
    s_sleep 4
    s_sub_u32 s10, s10, 1
    s_cbranch_scc0 GT_31
    s_mov_b32 s10, 0
GTD_32:
    buffer_load_dwordx4 v[4:7], v42, s[56:59], s8 offen offset:0 sc1
    buffer_load_dwordx4 v[8:11], v42, s[56:59], s8 offen offset:512 sc1
    buffer_load_dwordx4 v[12:15], v42, s[56:59], s8 offen offset:1024 sc1
    buffer_load_dwordx4 v[16:19], v42, s[56:59], s8 offen offset:1536 sc1
    buffer_load_dwordx4 v[20:23], v42, s[56:59], s9 offen offset:0 sc1
    buffer_load_dwordx4 v[24:27], v42, s[56:59], s9 offen offset:512 sc1
    buffer_load_dwordx4 v[28:31], v42, s[56:59], s9 offen offset:1024 sc1
    buffer_load_dwordx4 v[32:35], v42, s[56:59], s9 offen offset:1536 sc1
    s_waitcnt vmcnt(0)
PT_33:
    v_xor_b32 v44, s26, v5
    v_xor_b32 v45, s26, v7
    v_or_b32 v44, v44, v45
    v_xor_b32 v45, s26, v9
    v_or_b32 v44, v44, v45
    v_xor_b32 v45, s26, v11
    v_or_b32 v44, v44, v45
    v_xor_b32 v45, s26, v13
    v_or_b32 v44, v44, v45
    v_xor_b32 v45, s26, v15
    v_or_b32 v44, v44, v45
    v_xor_b32 v45, s26, v17
    v_or_b32 v44, v44, v45
    v_xor_b32 v45, s26, v19
    v_or_b32 v44, v44, v45
    v_xor_b32 v45, s26, v21
    v_or_b32 v44, v44, v45
    v_xor_b32 v45, s26, v23
    v_or_b32 v44, v44, v45
    v_xor_b32 v45, s26, v25
    v_or_b32 v44, v44, v45
    v_xor_b32 v45, s26, v27
    v_or_b32 v44, v44, v45
    v_xor_b32 v45, s26, v29
    v_or_b32 v44, v44, v45
    v_xor_b32 v45, s26, v31
    v_or_b32 v44, v44, v45
    v_xor_b32 v45, s26, v33
    v_or_b32 v44, v44, v45
    v_xor_b32 v45, s26, v35
    v_or_b32 v44, v44, v45
    v_cmp_ne_u32 vcc, 0, v44
    s_cbranch_vccz PTD_34
    s_sleep 4
    buffer_load_dwordx4 v[4:7], v42, s[56:59], s8 offen offset:0 sc1
    buffer_load_dwordx4 v[8:11], v42, s[56:59], s8 offen offset:512 sc1
    buffer_load_dwordx4 v[12:15], v42, s[56:59], s8 offen offset:1024 sc1
    buffer_load_dwordx4 v[16:19], v42, s[56:59], s8 offen offset:1536 sc1
    buffer_load_dwordx4 v[20:23], v42, s[56:59], s9 offen offset:0 sc1
    buffer_load_dwordx4 v[24:27], v42, s[56:59], s9 offen offset:512 sc1
    buffer_load_dwordx4 v[28:31], v42, s[56:59], s9 offen offset:1024 sc1
    buffer_load_dwordx4 v[32:35], v42, s[56:59], s9 offen offset:1536 sc1
    s_waitcnt vmcnt(0)
    s_sub_u32 s10, s10, 1
    s_cbranch_scc0 PT_33
    s_mov_b32 s10, 0
PTD_34:
    v_and_b32 v5, 0xffff0000, v4
    v_lshlrev_b32 v4, 16, v4
    v_and_b32 v21, 0xffff0000, v20
    v_lshlrev_b32 v20, 16, v20
    v_and_b32 v7, 0xffff0000, v6
    v_lshlrev_b32 v6, 16, v6
    v_and_b32 v23, 0xffff0000, v22
    v_lshlrev_b32 v22, 16, v22
    v_and_b32 v9, 0xffff0000, v8
    v_lshlrev_b32 v8, 16, v8
    v_and_b32 v25, 0xffff0000, v24
    v_lshlrev_b32 v24, 16, v24
    v_and_b32 v11, 0xffff0000, v10
    v_lshlrev_b32 v10, 16, v10
    v_and_b32 v27, 0xffff0000, v26
    v_lshlrev_b32 v26, 16, v26
    v_and_b32 v13, 0xffff0000, v12
    v_lshlrev_b32 v12, 16, v12
    v_and_b32 v29, 0xffff0000, v28
    v_lshlrev_b32 v28, 16, v28
    v_and_b32 v15, 0xffff0000, v14
    v_lshlrev_b32 v14, 16, v14
    v_and_b32 v31, 0xffff0000, v30
    v_lshlrev_b32 v30, 16, v30
    v_and_b32 v17, 0xffff0000, v16
    v_lshlrev_b32 v16, 16, v16
    v_and_b32 v33, 0xffff0000, v32
    v_lshlrev_b32 v32, 16, v32
    v_and_b32 v19, 0xffff0000, v18
    v_lshlrev_b32 v18, 16, v18
    v_and_b32 v35, 0xffff0000, v34
    v_lshlrev_b32 v34, 16, v34
    v_add_f32 v20, 1.0, v20
    v_add_f32 v21, 1.0, v21
    v_add_f32 v22, 1.0, v22
    v_add_f32 v23, 1.0, v23
    v_add_f32 v24, 1.0, v24
    v_add_f32 v25, 1.0, v25
    v_add_f32 v26, 1.0, v26
    v_add_f32 v27, 1.0, v27
    v_add_f32 v28, 1.0, v28
    v_add_f32 v29, 1.0, v29
    v_add_f32 v30, 1.0, v30
    v_add_f32 v31, 1.0, v31
    v_add_f32 v32, 1.0, v32
    v_add_f32 v33, 1.0, v33
    v_add_f32 v34, 1.0, v34
    v_add_f32 v35, 1.0, v35
    v_cvt_pk_bf16_f32 v20, 0, v20
    v_cvt_pk_bf16_f32 v21, 0, v21
    v_cvt_pk_bf16_f32 v22, 0, v22
    v_cvt_pk_bf16_f32 v23, 0, v23
    v_cvt_pk_bf16_f32 v24, 0, v24
    v_cvt_pk_bf16_f32 v25, 0, v25
    v_cvt_pk_bf16_f32 v26, 0, v26
    v_cvt_pk_bf16_f32 v27, 0, v27
    v_cvt_pk_bf16_f32 v28, 0, v28
    v_cvt_pk_bf16_f32 v29, 0, v29
    v_cvt_pk_bf16_f32 v30, 0, v30
    v_cvt_pk_bf16_f32 v31, 0, v31
    v_cvt_pk_bf16_f32 v32, 0, v32
    v_cvt_pk_bf16_f32 v33, 0, v33
    v_cvt_pk_bf16_f32 v34, 0, v34
    v_cvt_pk_bf16_f32 v35, 0, v35
    v_mul_f32 v52, v52, v20
    v_mul_f32 v53, v53, v21
    v_mul_f32 v54, v54, v22
    v_mul_f32 v55, v55, v23
    v_mul_f32 v56, v56, v24
    v_mul_f32 v57, v57, v25
    v_mul_f32 v58, v58, v26
    v_mul_f32 v59, v59, v27
    v_mul_f32 v60, v60, v28
    v_mul_f32 v61, v61, v29
    v_mul_f32 v62, v62, v30
    v_mul_f32 v63, v63, v31
    v_mul_f32 v64, v64, v32
    v_mul_f32 v65, v65, v33
    v_mul_f32 v66, v66, v34
    v_mul_f32 v67, v67, v35
    v_cvt_pk_bf16_f32 v52, 0, v52
    v_cvt_pk_bf16_f32 v53, 0, v53
    v_cvt_pk_bf16_f32 v54, 0, v54
    v_cvt_pk_bf16_f32 v55, 0, v55
    v_cvt_pk_bf16_f32 v56, 0, v56
    v_cvt_pk_bf16_f32 v57, 0, v57
    v_cvt_pk_bf16_f32 v58, 0, v58
    v_cvt_pk_bf16_f32 v59, 0, v59
    v_cvt_pk_bf16_f32 v60, 0, v60
    v_cvt_pk_bf16_f32 v61, 0, v61
    v_cvt_pk_bf16_f32 v62, 0, v62
    v_cvt_pk_bf16_f32 v63, 0, v63
    v_cvt_pk_bf16_f32 v64, 0, v64
    v_cvt_pk_bf16_f32 v65, 0, v65
    v_cvt_pk_bf16_f32 v66, 0, v66
    v_cvt_pk_bf16_f32 v67, 0, v67
    v_add_f32 v52, v52, v4
    v_add_f32 v53, v53, v5
    v_add_f32 v54, v54, v6
    v_add_f32 v55, v55, v7
    v_add_f32 v56, v56, v8
    v_add_f32 v57, v57, v9
    v_add_f32 v58, v58, v10
    v_add_f32 v59, v59, v11
    v_add_f32 v60, v60, v12
    v_add_f32 v61, v61, v13
    v_add_f32 v62, v62, v14
    v_add_f32 v63, v63, v15
    v_add_f32 v64, v64, v16
    v_add_f32 v65, v65, v17
    v_add_f32 v66, v66, v18
    v_add_f32 v67, v67, v19
L_act:
    s_lshl_b32 s7, s47, 11
    v_lshlrev_b32 v42, 10, v40
    v_lshl_add_u32 v42, v41, 3, v42
    v_add_u32 v42, s7, v42
    v_cvt_pk_bf16_f32 v44, v52, v53
    v_cvt_pk_bf16_f32 v45, v54, v55
    v_cvt_pk_bf16_f32 v46, v56, v57
    v_cvt_pk_bf16_f32 v47, v58, v59
    v_cvt_pk_bf16_f32 v48, v60, v61
    v_cvt_pk_bf16_f32 v49, v62, v63
    v_cvt_pk_bf16_f32 v50, v64, v65
    v_cvt_pk_bf16_f32 v51, v66, v67
    ds_write_b64 v42, v[44:45] offset:8192
    ds_write_b64 v42, v[46:47] offset:8448
    ds_write_b64 v42, v[48:49] offset:8704
    ds_write_b64 v42, v[50:51] offset:8960
    v_mov_b32 v6, 1
    v_mov_b32 v7, 0
    s_mov_b64 exec, 1
    ds_add_u32 v7, v6 offset:40
    s_mov_b64 exec, -1
    s_lshl_b32 s8, s47, 15
    s_add_u32 s8, s8, 14336
    v_lshl_add_u32 v37, v1, 4, s8
    v_mov_b32 v39, 0
LW_35:
    ds_read_b32 v38, v39 offset:36
    s_waitcnt lgkmcnt(0)
    v_readfirstlane_b32 s7, v38
    s_cmp_ge_u32 s7, 2
    s_cbranch_scc1 LWD_36
    s_sleep 1
    s_sub_u32 s10, s10, 1
    s_cbranch_scc0 LW_35
    s_mov_b32 s10, 0
LWD_36:
    s_nop 4
    ds_read_b128 v[128:131], v37 offset:0
    ds_read_b128 v[132:135], v37 offset:1024
    ds_read_b128 v[136:139], v37 offset:2048
    ds_read_b128 v[140:143], v37 offset:3072
    ds_read_b128 v[144:147], v37 offset:4096
    ds_read_b128 v[148:151], v37 offset:5120
    ds_read_b128 v[152:155], v37 offset:6144
    ds_read_b128 v[156:159], v37 offset:7168
    s_waitcnt lgkmcnt(4)
    ds_read_b128 v[160:163], v37 offset:8192
    ds_read_b128 v[164:167], v37 offset:9216
    ds_read_b128 v[168:171], v37 offset:10240
    ds_read_b128 v[172:175], v37 offset:11264
    ds_read_b128 v[176:179], v37 offset:12288
    ds_read_b128 v[180:183], v37 offset:13312
    ds_read_b128 v[184:187], v37 offset:14336
    ds_read_b128 v[188:191], v37 offset:15360
    s_waitcnt lgkmcnt(4)
    ds_read_b128 v[192:195], v37 offset:16384
    ds_read_b128 v[196:199], v37 offset:17408
    ds_read_b128 v[200:203], v37 offset:18432
    ds_read_b128 v[204:207], v37 offset:19456
    ds_read_b128 v[208:211], v37 offset:20480
    ds_read_b128 v[212:215], v37 offset:21504
    ds_read_b128 v[216:219], v37 offset:22528
    ds_read_b128 v[220:223], v37 offset:23552
    s_waitcnt lgkmcnt(4)
    ds_read_b128 v[224:227], v37 offset:24576
    ds_read_b128 v[228:231], v37 offset:25600
    ds_read_b128 v[232:235], v37 offset:26624
    ds_read_b128 v[236:239], v37 offset:27648
    ds_read_b128 v[240:243], v37 offset:28672
    ds_read_b128 v[244:247], v37 offset:29696
    ds_read_b128 v[248:251], v37 offset:30720
    ds_read_b128 v[252:255], v37 offset:31744
    s_waitcnt lgkmcnt(0)
    s_lshl_b32 s8, s47, 11
    s_add_u32 s8, s8, 512
    s_branch L_gemv
.p2align 6
L_step:
    s_cmp_gt_i32 s83, s81
    s_cbranch_scc1 L_own
L_step1:
    ds_read_b32 v6, v7 offset:228
    s_sub_u32 s10, s10, 1
    s_cbranch_scc1 L_step2
    s_waitcnt lgkmcnt(0)
    v_readfirstlane_b32 s82, v6
    s_cmp_ge_i32 s82, s83
    s_cbranch_scc0 L_step1
    s_setpc_b64 s[36:37]
L_step2:
    s_mov_b32 s10, 0
    s_waitcnt lgkmcnt(0)
    s_setpc_b64 s[36:37]
L_own:
    s_cmp_ge_u32 s38, 8
    s_cbranch_scc1 OW_37
    s_cmp_ge_u32 s38, 6
    s_cbranch_scc1 OW_38
    s_cmp_ge_u32 s38, 5
    s_cbranch_scc1 OW_39
    s_waitcnt vmcnt(12)
    s_setpc_b64 s[36:37]
OW_39:
    s_waitcnt vmcnt(16)
    s_setpc_b64 s[36:37]
OW_38:
    s_cmp_ge_u32 s38, 7
    s_cbranch_scc1 OW_40
    s_waitcnt vmcnt(20)
    s_setpc_b64 s[36:37]
OW_40:
    s_waitcnt vmcnt(24)
    s_setpc_b64 s[36:37]
OW_37:
    s_cmp_ge_u32 s38, 10
    s_cbranch_scc1 OW_41
    s_cmp_ge_u32 s38, 9
    s_cbranch_scc1 OW_42
    s_waitcnt vmcnt(28)
    s_setpc_b64 s[36:37]
OW_42:
    s_waitcnt vmcnt(32)
    s_setpc_b64 s[36:37]
OW_41:
    s_cmp_ge_u32 s38, 11
    s_cbranch_scc1 OW_43
    s_waitcnt vmcnt(36)
    s_setpc_b64 s[36:37]
OW_43:
    s_waitcnt vmcnt(40)
    s_setpc_b64 s[36:37]
L_w27:
    s_load_dword s46, s[34:35], 0
    s_load_dword s26, s[44:45], 327680
    s_waitcnt lgkmcnt(0)
    s_mul_i32 s26, s26, 0x9e3779b1
    s_add_u32 s26, s26, 0x7f4a7c15
    s_lshl_b32 s7, s2, 2
    s_add_u32 s7, s7, 262144
    v_mov_b32 v126, s26
    v_mov_b32 v124, 0
    s_mov_b64 exec, 1
    s_waitcnt vmcnt(0)
    buffer_store_dword v126, v124, s[56:59], s7 offen sc1
    s_mov_b64 exec, -1
    s_branch L_tab
L_w6:
    s_cmp_lg_u32 s42, 0
    s_cbranch_scc1 L_stream
    s_waitcnt vmcnt(4)
    v_mov_b32 v7, 0
    s_mov_b64 exec, 1
    v_mov_b32 v6, 4
    ds_add_u32 v7, v6 offset:232
    v_mov_b32 v6, 1
    ds_add_u32 v7, v6 offset:224
    s_waitcnt vmcnt(1)
    v_mov_b32 v6, 2
    ds_add_u32 v7, v6 offset:228
    s_waitcnt vmcnt(0)
    v_mov_b32 v6, 2
    ds_add_u32 v7, v6 offset:228
    s_mov_b64 exec, -1
L_stream:
    v_lshrrev_b32 v4, 1, v3
    v_lshlrev_b32 v4, 8, v4
    v_lshl_add_u32 v4, v2, 5, v4
    v_and_b32 v5, 1, v3
    v_lshl_add_u32 v4, v5, 4, v4
    v_lshlrev_b32 v5, 9, v2
    v_lshl_add_u32 v5, v3, 4, v5
    s_mov_b32 s47, 0
    s_setprio 2
    s_sub_u32 s27, s3, 1
    s_cmp_eq_u32 s3, 2
    s_cselect_b32 s7, s0, s1
    s_add_u32 s27, s27, s7
    v_mov_b32 v7, 0
AQ_44:
    ds_read_b128 v[40:43], v7 offset:224
    s_waitcnt lgkmcnt(0)
    v_readfirstlane_b32 s7, v40
    s_cmp_ge_u32 s7, s27
    s_cbranch_scc1 AQD_45
    s_sleep 1
    s_sub_u32 s10, s10, 1
    s_cbranch_scc0 AQ_44
    s_mov_b32 s10, 0
AQD_45:
    v_readfirstlane_b32 s82, v41
    v_readfirstlane_b32 s81, v42
    v_readfirstlane_b32 s38, v43
    s_cmp_eq_u32 s42, 0
    s_cselect_b32 s7, 6, 8
    s_cmp_eq_u32 s38, 0
    s_cselect_b32 s38, s7, s38
    s_sub_u32 s83, s81, s38
    s_add_u32 s83, s83, 1
    s_cmp_lg_u32 s3, 2
    s_cbranch_scc1 L_kall
    s_or_b32 s7, s42, s0
    s_cselect_b32 s7, 0, 3
    s_add_u32 s83, s83, s7
    s_branch L_krest
L_kall:
    s_cmp_ge_i32 s82, s83
    s_cbranch_scc1 ST_46
    s_call_b64 s[36:37], L_step
ST_46:
    s_add_u32 s83, s83, 1
    s_add_u32 s8, s13, 0
    buffer_load_dwordx4 v[128:131], v4, s[48:51], s8 offen offset:0 nt
    buffer_load_dwordx4 v[132:135], v4, s[48:51], s8 offen offset:128 nt
    buffer_load_dwordx4 v[136:139], v4, s[48:51], s8 offen offset:2048 nt
    buffer_load_dwordx4 v[140:143], v4, s[48:51], s8 offen offset:2176 nt
    s_cmp_ge_i32 s82, s83
    s_cbranch_scc1 ST_47
    s_call_b64 s[36:37], L_step
ST_47:
    s_add_u32 s83, s83, 1
    s_add_u32 s8, s13, 4096
    buffer_load_dwordx4 v[144:147], v4, s[48:51], s8 offen offset:0 nt
    buffer_load_dwordx4 v[148:151], v4, s[48:51], s8 offen offset:128 nt
    buffer_load_dwordx4 v[152:155], v4, s[48:51], s8 offen offset:2048 nt
    buffer_load_dwordx4 v[156:159], v4, s[48:51], s8 offen offset:2176 nt
    s_cmp_ge_i32 s82, s83
    s_cbranch_scc1 ST_48
    s_call_b64 s[36:37], L_step
ST_48:
    s_add_u32 s83, s83, 1
    s_add_u32 s8, s13, 8192
    buffer_load_dwordx4 v[160:163], v4, s[48:51], s8 offen offset:0 nt
    buffer_load_dwordx4 v[164:167], v4, s[48:51], s8 offen offset:128 nt
    buffer_load_dwordx4 v[168:171], v4, s[48:51], s8 offen offset:2048 nt
    buffer_load_dwordx4 v[172:175], v4, s[48:51], s8 offen offset:2176 nt
L_krest:
    s_cmp_ge_i32 s82, s83
    s_cbranch_scc1 ST_49
    s_call_b64 s[36:37], L_step
ST_49:
    s_add_u32 s83, s83, 1
    s_add_u32 s8, s13, 12288
    buffer_load_dwordx4 v[176:179], v4, s[48:51], s8 offen offset:0 nt
    buffer_load_dwordx4 v[180:183], v4, s[48:51], s8 offen offset:128 nt
    buffer_load_dwordx4 v[184:187], v4, s[48:51], s8 offen offset:2048 nt
    buffer_load_dwordx4 v[188:191], v4, s[48:51], s8 offen offset:2176 nt
    s_cmp_ge_i32 s82, s83
    s_cbranch_scc1 ST_50
    s_call_b64 s[36:37], L_step
ST_50:
    s_add_u32 s83, s83, 1
    s_add_u32 s8, s13, 16384
    buffer_load_dwordx4 v[192:195], v4, s[48:51], s8 offen offset:0 nt
    buffer_load_dwordx4 v[196:199], v4, s[48:51], s8 offen offset:128 nt
    buffer_load_dwordx4 v[200:203], v4, s[48:51], s8 offen offset:2048 nt
    buffer_load_dwordx4 v[204:207], v4, s[48:51], s8 offen offset:2176 nt
    s_cmp_ge_i32 s82, s83
    s_cbranch_scc1 ST_51
    s_call_b64 s[36:37], L_step
ST_51:
    s_add_u32 s83, s83, 1
    s_add_u32 s8, s13, 20480
    buffer_load_dwordx4 v[208:211], v4, s[48:51], s8 offen offset:0 nt
    buffer_load_dwordx4 v[212:215], v4, s[48:51], s8 offen offset:128 nt
    buffer_load_dwordx4 v[216:219], v4, s[48:51], s8 offen offset:2048 nt
    buffer_load_dwordx4 v[220:223], v4, s[48:51], s8 offen offset:2176 nt
    s_cmp_ge_i32 s82, s83
    s_cbranch_scc1 ST_52
    s_call_b64 s[36:37], L_step
ST_52:
    s_add_u32 s83, s83, 1
    s_add_u32 s8, s13, 24576
    buffer_load_dwordx4 v[224:227], v4, s[48:51], s8 offen offset:0 nt
    buffer_load_dwordx4 v[228:231], v4, s[48:51], s8 offen offset:128 nt
    buffer_load_dwordx4 v[232:235], v4, s[48:51], s8 offen offset:2048 nt
    buffer_load_dwordx4 v[236:239], v4, s[48:51], s8 offen offset:2176 nt
    s_cmp_ge_i32 s82, s83
    s_cbranch_scc1 ST_53
    s_call_b64 s[36:37], L_step
ST_53:
    s_add_u32 s83, s83, 1
    s_add_u32 s8, s13, 28672
    buffer_load_dwordx4 v[240:243], v4, s[48:51], s8 offen offset:0 nt
    buffer_load_dwordx4 v[244:247], v4, s[48:51], s8 offen offset:128 nt
    buffer_load_dwordx4 v[248:251], v4, s[48:51], s8 offen offset:2048 nt
    buffer_load_dwordx4 v[252:255], v4, s[48:51], s8 offen offset:2176 nt
    s_cmp_gt_u32 s3, 3
    s_cbranch_scc1 L_nodma
    s_lshl_b32 s9, s3, 15
    s_add_u32 s9, s9, 14336
    s_cmp_ge_i32 s82, s83
    s_cbranch_scc1 ST_54
    s_call_b64 s[36:37], L_step
ST_54:
    s_add_u32 s83, s83, 1
    s_add_u32 s8, s13, -65536
    s_add_u32 m0, s9, 0
    s_nop 0
    buffer_load_dwordx4 v4, s[48:51], s8 offen offset:0 nt lds
    s_add_u32 m0, s9, 896
    s_nop 0
    buffer_load_dwordx4 v4, s[48:51], s8 offen offset:128 nt lds
    s_add_u32 m0, s9, 0
    s_nop 0
    buffer_load_dwordx4 v4, s[48:51], s8 offen offset:2048 nt lds
    s_add_u32 m0, s9, 896
    s_nop 0
    buffer_load_dwordx4 v4, s[48:51], s8 offen offset:2176 nt lds
    s_cmp_ge_i32 s82, s83
    s_cbranch_scc1 ST_55
    s_call_b64 s[36:37], L_step
ST_55:
    s_add_u32 s83, s83, 1
    s_add_u32 s8, s13, -61440
    s_add_u32 m0, s9, 4096
    s_nop 0
    buffer_load_dwordx4 v4, s[48:51], s8 offen offset:0 nt lds
    s_add_u32 m0, s9, 4992
    s_nop 0
    buffer_load_dwordx4 v4, s[48:51], s8 offen offset:128 nt lds
    s_add_u32 m0, s9, 4096
    s_nop 0
    buffer_load_dwordx4 v4, s[48:51], s8 offen offset:2048 nt lds
    s_add_u32 m0, s9, 4992
    s_nop 0
    buffer_load_dwordx4 v4, s[48:51], s8 offen offset:2176 nt lds
    s_cmp_ge_i32 s82, s83
    s_cbranch_scc1 ST_56
    s_call_b64 s[36:37], L_step
ST_56:
    s_add_u32 s83, s83, 1
    s_add_u32 s8, s13, -57344
    s_add_u32 m0, s9, 8192
    s_nop 0
    buffer_load_dwordx4 v4, s[48:51], s8 offen offset:0 nt lds
    s_add_u32 m0, s9, 9088
    s_nop 0
    buffer_load_dwordx4 v4, s[48:51], s8 offen offset:128 nt lds
    s_add_u32 m0, s9, 8192
    s_nop 0
    buffer_load_dwordx4 v4, s[48:51], s8 offen offset:2048 nt lds
    s_add_u32 m0, s9, 9088
    s_nop 0
    buffer_load_dwordx4 v4, s[48:51], s8 offen offset:2176 nt lds
    s_cmp_ge_i32 s82, s83
    s_cbranch_scc1 ST_57
    s_call_b64 s[36:37], L_step
ST_57:
    s_add_u32 s83, s83, 1
    s_add_u32 s8, s13, -53248
    s_add_u32 m0, s9, 12288
    s_nop 0
    buffer_load_dwordx4 v4, s[48:51], s8 offen offset:0 nt lds
    s_add_u32 m0, s9, 13184
    s_nop 0
    buffer_load_dwordx4 v4, s[48:51], s8 offen offset:128 nt lds
    s_add_u32 m0, s9, 12288
    s_nop 0
    buffer_load_dwordx4 v4, s[48:51], s8 offen offset:2048 nt lds
    s_add_u32 m0, s9, 13184
    s_nop 0
    buffer_load_dwordx4 v4, s[48:51], s8 offen offset:2176 nt lds
    s_cmp_ge_i32 s82, s83
    s_cbranch_scc1 ST_58
    s_call_b64 s[36:37], L_step
ST_58:
    s_add_u32 s83, s83, 1
    s_add_u32 s8, s13, -49152
    s_add_u32 m0, s9, 16384
    s_nop 0
    buffer_load_dwordx4 v4, s[48:51], s8 offen offset:0 nt lds
    s_add_u32 m0, s9, 17280
    s_nop 0
    buffer_load_dwordx4 v4, s[48:51], s8 offen offset:128 nt lds
    s_add_u32 m0, s9, 16384
    s_nop 0
    buffer_load_dwordx4 v4, s[48:51], s8 offen offset:2048 nt lds
    s_add_u32 m0, s9, 17280
    s_nop 0
    buffer_load_dwordx4 v4, s[48:51], s8 offen offset:2176 nt lds
    s_cmp_ge_i32 s82, s83
    s_cbranch_scc1 ST_59
    s_call_b64 s[36:37], L_step
ST_59:
    s_add_u32 s83, s83, 1
    s_add_u32 s8, s13, -45056
    s_add_u32 m0, s9, 20480
    s_nop 0
    buffer_load_dwordx4 v4, s[48:51], s8 offen offset:0 nt lds
    s_add_u32 m0, s9, 21376
    s_nop 0
    buffer_load_dwordx4 v4, s[48:51], s8 offen offset:128 nt lds
    s_add_u32 m0, s9, 20480
    s_nop 0
    buffer_load_dwordx4 v4, s[48:51], s8 offen offset:2048 nt lds
    s_add_u32 m0, s9, 21376
    s_nop 0
    buffer_load_dwordx4 v4, s[48:51], s8 offen offset:2176 nt lds
    s_cmp_ge_i32 s82, s83
    s_cbranch_scc1 ST_60
    s_call_b64 s[36:37], L_step
ST_60:
    s_add_u32 s83, s83, 1
    s_add_u32 s8, s13, -40960
    s_add_u32 m0, s9, 24576
    s_nop 0
    buffer_load_dwordx4 v4, s[48:51], s8 offen offset:0 nt lds
    s_add_u32 m0, s9, 25472
    s_nop 0
    buffer_load_dwordx4 v4, s[48:51], s8 offen offset:128 nt lds
    s_add_u32 m0, s9, 24576
    s_nop 0
    buffer_load_dwordx4 v4, s[48:51], s8 offen offset:2048 nt lds
    s_add_u32 m0, s9, 25472
    s_nop 0
    buffer_load_dwordx4 v4, s[48:51], s8 offen offset:2176 nt lds
    s_cmp_ge_i32 s82, s83
    s_cbranch_scc1 ST_61
    s_call_b64 s[36:37], L_step
ST_61:
    s_add_u32 s83, s83, 1
    s_add_u32 s8, s13, -36864
    s_add_u32 m0, s9, 28672
    s_nop 0
    buffer_load_dwordx4 v4, s[48:51], s8 offen offset:0 nt lds
    s_add_u32 m0, s9, 29568
    s_nop 0
    buffer_load_dwordx4 v4, s[48:51], s8 offen offset:128 nt lds
    s_add_u32 m0, s9, 28672
    s_nop 0
    buffer_load_dwordx4 v4, s[48:51], s8 offen offset:2048 nt lds
    s_add_u32 m0, s9, 29568
    s_nop 0
    buffer_load_dwordx4 v4, s[48:51], s8 offen offset:2176 nt lds
L_nodma:
    v_mov_b32 v7, 0
    s_mov_b64 exec, 1
    v_mov_b32 v6, 12
    ds_add_u32 v7, v6 offset:232
    v_mov_b32 v6, 1
    ds_add_u32 v7, v6 offset:224
    s_waitcnt vmcnt(44)
    ds_add_u32 v7, v6 offset:228
    s_waitcnt vmcnt(40)
    ds_add_u32 v7, v6 offset:228
    s_waitcnt vmcnt(36)
    ds_add_u32 v7, v6 offset:228
    s_waitcnt vmcnt(32)
    ds_add_u32 v7, v6 offset:228
    s_waitcnt vmcnt(28)
    ds_add_u32 v7, v6 offset:228
    s_waitcnt vmcnt(24)
    ds_add_u32 v7, v6 offset:228
    s_waitcnt vmcnt(20)
    ds_add_u32 v7, v6 offset:228
    s_waitcnt vmcnt(16)
    ds_add_u32 v7, v6 offset:228
    s_waitcnt vmcnt(12)
    ds_add_u32 v7, v6 offset:228
    s_waitcnt vmcnt(8)
    ds_add_u32 v7, v6 offset:228
    s_waitcnt vmcnt(4)
    ds_add_u32 v7, v6 offset:228
    s_waitcnt vmcnt(0)
    ds_add_u32 v7, v6 offset:228
    s_mov_b64 exec, -1
    s_cmp_gt_u32 s3, 3
    s_cbranch_scc1 L_w47
    s_cmp_eq_u32 s3, 2
    s_cbranch_scc1 L_getq
    s_branch L_q1st
L_w47:
    s_cmp_lt_u32 s3, 6
    s_cbranch_scc1 L_vtick
    s_lshr_b32 s8, s6, 3
    s_cmp_lg_u32 s8, 2
    s_cbranch_scc1 L_vtick
L_q1st:
    v_mov_b32 v7, 0
LW_62:
    ds_read_b32 v6, v7 offset:4
    s_waitcnt lgkmcnt(0)
    v_readfirstlane_b32 s7, v6
    s_cmp_ge_u32 s7, 1
    s_cbranch_scc1 LWD_63
    s_sleep 2
    s_sub_u32 s10, s10, 1
    s_cbranch_scc0 LW_62
    s_mov_b32 s10, 0
LWD_63:
    s_nop 4
    s_mov_b32 s47, 2
    s_waitcnt vmcnt(0)
    s_branch L_qk
L_helper:
    v_lshrrev_b32 v4, 1, v3
    v_lshlrev_b32 v4, 8, v4
    v_lshl_add_u32 v4, v2, 5, v4
    v_and_b32 v5, 1, v3
    v_lshl_add_u32 v4, v5, 4, v4
    v_lshlrev_b32 v5, 9, v2
    v_lshl_add_u32 v5, v3, 4, v5
    s_mov_b32 s47, 0
    s_branch L_tab
L_getq:
    s_load_dword s46, s[34:35], 0
    s_load_dword s26, s[44:45], 327680
    s_waitcnt lgkmcnt(0)
    s_mul_i32 s26, s26, 0x9e3779b1
    s_add_u32 s26, s26, 0x7f4a7c15
    s_cmp_eq_u32 s42, 0
    s_cselect_b32 s8, 3, 2
    s_add_u32 s8, s8, s1
    v_mov_b32 v41, 0
LW_64:
    ds_read_b32 v40, v41 offset:224
    s_waitcnt lgkmcnt(0)
    v_readfirstlane_b32 s7, v40
    s_cmp_ge_u32 s7, s8
    s_cbranch_scc1 LWD_65
    s_sleep 2
    s_sub_u32 s10, s10, 1
    s_cbranch_scc0 LW_64
    s_mov_b32 s10, 0
LWD_65:
    s_nop 4
    s_lshr_b32 s7, s5, 2
    s_mul_i32 s7, s7, 40960
    s_and_b32 s9, s5, 3
    s_lshl_b32 s8, s9, 12
    s_add_u32 s8, s8, s7
    s_add_u32 s8, s8, 24576
    s_lshl_b32 s7, s9, 3
    s_and_b32 s9, s6, 7
    s_add_u32 s7, s7, s9
    s_mul_i32 s7, s7, 1280
    s_add_u32 s7, s7, 872448
    s_mov_b32 s9, 262144
    v_lshlrev_b32 v42, 4, v1
    v_lshrrev_b32 v40, 5, v1
    v_and_b32 v41, 31, v1
    v_mul_u32_u24 v43, 272, v40
    v_lshl_add_u32 v43, v41, 3, v43
GT_66:
    s_load_dwordx16 s[72:87], s[44:45], s7 glc
    s_waitcnt lgkmcnt(0)
    s_xor_b32 s72, s72, s26
    s_xor_b32 s73, s73, s26
    s_xor_b32 s74, s74, s26
    s_xor_b32 s75, s75, s26
    s_xor_b32 s76, s76, s26
    s_xor_b32 s77, s77, s26
    s_xor_b32 s78, s78, s26
    s_xor_b32 s79, s79, s26
    s_xor_b32 s80, s80, s26
    s_xor_b32 s81, s81, s26
    s_xor_b32 s82, s82, s26
    s_xor_b32 s83, s83, s26
    s_xor_b32 s84, s84, s26
    s_xor_b32 s85, s85, s26
    s_xor_b32 s86, s86, s26
    s_xor_b32 s87, s87, s26
    s_or_b64 s[72:73], s[72:73], s[74:75]
    s_or_b64 s[72:73], s[72:73], s[76:77]
    s_or_b64 s[72:73], s[72:73], s[78:79]
    s_or_b64 s[72:73], s[72:73], s[80:81]
    s_or_b64 s[72:73], s[72:73], s[82:83]
    s_or_b64 s[72:73], s[72:73], s[84:85]
    s_or_b64 s[72:73], s[72:73], s[86:87]
    s_cbranch_scc0 GTD_67
    s_sleep 8
    s_sub_u32 s10, s10, 1
    s_cbranch_scc0 GT_66
    s_mov_b32 s10, 0
GTD_67:
    buffer_load_dwordx4 v[48:51], v42, s[56:59], s8 offen offset:0 sc1
    buffer_load_dwordx4 v[52:55], v42, s[56:59], s8 offen offset:1024 sc1
    buffer_load_dwordx4 v[56:59], v42, s[56:59], s8 offen offset:2048 sc1
    buffer_load_dwordx4 v[60:63], v42, s[56:59], s8 offen offset:3072 sc1
    buffer_load_dwordx4 v[64:67], v42, s[56:59], s9 offen sc1
    s_waitcnt vmcnt(0)
PT_68:
    v_xor_b32 v44, s26, v49
    v_xor_b32 v45, s26, v51
    v_or_b32 v44, v44, v45
    v_xor_b32 v45, s26, v53
    v_or_b32 v44, v44, v45
    v_xor_b32 v45, s26, v55
    v_or_b32 v44, v44, v45
    v_xor_b32 v45, s26, v57
    v_or_b32 v44, v44, v45
    v_xor_b32 v45, s26, v59
    v_or_b32 v44, v44, v45
    v_xor_b32 v45, s26, v61
    v_or_b32 v44, v44, v45
    v_xor_b32 v45, s26, v63
    v_or_b32 v44, v44, v45
    v_xor_b32 v45, s26, v64
    v_or_b32 v44, v44, v45
    v_xor_b32 v45, s26, v65
    v_or_b32 v44, v44, v45
    v_xor_b32 v45, s26, v66
    v_or_b32 v44, v44, v45
    v_xor_b32 v45, s26, v67
    v_or_b32 v44, v44, v45
    v_cmp_ne_u32 vcc, 0, v44
    s_cbranch_vccz PTD_69
    s_sleep 4
    buffer_load_dwordx4 v[48:51], v42, s[56:59], s8 offen offset:0 sc1
    buffer_load_dwordx4 v[52:55], v42, s[56:59], s8 offen offset:1024 sc1
    buffer_load_dwordx4 v[56:59], v42, s[56:59], s8 offen offset:2048 sc1
    buffer_load_dwordx4 v[60:63], v42, s[56:59], s8 offen offset:3072 sc1
    buffer_load_dwordx4 v[64:67], v42, s[56:59], s9 offen sc1
    s_waitcnt vmcnt(0)
    s_sub_u32 s10, s10, 1
    s_cbranch_scc0 PT_68
    s_mov_b32 s10, 0
PTD_69:
    v_mov_b32 v49, v50
    ds_write_b64 v43, v[48:49] offset:5120
    v_mov_b32 v53, v54
    ds_write_b64 v43, v[52:53] offset:5664
    v_mov_b32 v57, v58
    ds_write_b64 v43, v[56:57] offset:6208
    v_mov_b32 v61, v62
    ds_write_b64 v43, v[60:61] offset:6752
    v_mov_b32 v44, 1
    v_mov_b32 v45, 0
    ds_write_b32 v45, v44 offset:4
    s_mov_b32 s47, 2
    s_branch L_qk
L_vtick:
    s_mov_b32 s0, 0
    v_mov_b32 v6, 1
    v_mov_b32 v7, 0
    s_mov_b64 exec, 1
    ds_add_rtn_u32 v6, v7, v6 offset:32
    s_mov_b64 exec, -1
    s_waitcnt lgkmcnt(0)
    v_readfirstlane_b32 s27, v6
    s_add_u32 s27, s27, 7
    s_add_u32 s27, s27, s1
    s_lshl_b32 s7, s3, 2
    s_add_u32 s7, s7, 24
    s_cmp_lt_u32 s3, 2
    s_cselect_b32 s7, s7, 4
    v_mov_b32 v9, s7
L_waitv:
    s_setprio 2
    v_mov_b32 v8, 0
    ds_read_b32 v6, v8 offset:224
    ds_read_b32 v7, v9
    ds_read_b32 v8, v8 offset:12
    s_waitcnt lgkmcnt(0)
    v_readfirstlane_b32 s7, v6
    v_readfirstlane_b32 s8, v7
    v_readfirstlane_b32 s9, v8
    s_cmp_ge_u32 s7, s27
    s_nop 2
    s_cbranch_scc1 L_issuev
    s_cmp_gt_u32 s9, s0
    s_cbranch_scc1 L_pack
    s_cmp_gt_u32 s8, s47
    s_cbranch_scc0 L_waitv2
    s_mov_b32 s47, 1
    s_waitcnt vmcnt(0)
    s_branch L_hk
L_waitv2:
    s_sleep 1
    s_sub_u32 s10, s10, 1
    s_cbranch_scc0 L_waitv
    s_mov_b32 s10, 0
L_issuev:
    v_mov_b32 v7, 0
AQ_70:
    ds_read_b128 v[40:43], v7 offset:224
    s_waitcnt lgkmcnt(0)
    v_readfirstlane_b32 s82, v41
    v_readfirstlane_b32 s81, v42
    v_readfirstlane_b32 s38, v43
    s_cmp_eq_u32 s42, 0
    s_cselect_b32 s7, 6, 8
    s_cmp_eq_u32 s38, 0
    s_cselect_b32 s38, s7, s38
    s_sub_u32 s83, s81, s38
    s_add_u32 s83, s83, 1
    s_cmp_ge_i32 s82, s83
    s_cbranch_scc1 ST_72
    s_call_b64 s[36:37], L_step
ST_72:
    s_add_u32 s83, s83, 1
    s_add_u32 s8, s13, 0
    buffer_load_dwordx4 v[48:51], v5, s[52:55], s8 offen offset:0 nt
    buffer_load_dwordx4 v[52:55], v5, s[52:55], s8 offen offset:256 nt
    buffer_load_dwordx4 v[56:59], v5, s[52:55], s8 offen offset:2048 nt
    buffer_load_dwordx4 v[60:63], v5, s[52:55], s8 offen offset:2304 nt
    s_cmp_ge_i32 s82, s83
    s_cbranch_scc1 ST_73
    s_call_b64 s[36:37], L_step
ST_73:
    s_add_u32 s83, s83, 1
    s_add_u32 s8, s13, 4096
    buffer_load_dwordx4 v[64:67], v5, s[52:55], s8 offen offset:0 nt
    buffer_load_dwordx4 v[68:71], v5, s[52:55], s8 offen offset:256 nt
    buffer_load_dwordx4 v[72:75], v5, s[52:55], s8 offen offset:2048 nt
    buffer_load_dwordx4 v[76:79], v5, s[52:55], s8 offen offset:2304 nt
    s_cmp_ge_i32 s82, s83
    s_cbranch_scc1 ST_74
    s_call_b64 s[36:37], L_step
ST_74:
    s_add_u32 s83, s83, 1
    s_add_u32 s8, s13, 8192
    buffer_load_dwordx4 v[80:83], v5, s[52:55], s8 offen offset:0 nt
    buffer_load_dwordx4 v[84:87], v5, s[52:55], s8 offen offset:256 nt
    buffer_load_dwordx4 v[88:91], v5, s[52:55], s8 offen offset:2048 nt
    buffer_load_dwordx4 v[92:95], v5, s[52:55], s8 offen offset:2304 nt
    s_cmp_ge_i32 s82, s83
    s_cbranch_scc1 ST_75
    s_call_b64 s[36:37], L_step
ST_75:
    s_add_u32 s83, s83, 1
    s_add_u32 s8, s13, 12288
    buffer_load_dwordx4 v[96:99], v5, s[52:55], s8 offen offset:0 nt
    buffer_load_dwordx4 v[100:103], v5, s[52:55], s8 offen offset:256 nt
    buffer_load_dwordx4 v[104:107], v5, s[52:55], s8 offen offset:2048 nt
    buffer_load_dwordx4 v[108:111], v5, s[52:55], s8 offen offset:2304 nt
    s_cmp_ge_i32 s82, s83
    s_cbranch_scc1 ST_76
    s_call_b64 s[36:37], L_step
ST_76:
    s_add_u32 s83, s83, 1
    s_add_u32 s8, s13, 16384
    buffer_load_dwordx4 v[112:115], v5, s[52:55], s8 offen offset:0 nt
    buffer_load_dwordx4 v[116:119], v5, s[52:55], s8 offen offset:256 nt
    buffer_load_dwordx4 v[120:123], v5, s[52:55], s8 offen offset:2048 nt
    buffer_load_dwordx4 v[124:127], v5, s[52:55], s8 offen offset:2304 nt
    s_cmp_eq_u32 s47, 1
    s_cbranch_scc0 L_part
    v_mov_b32 v6, 1
    v_mov_b32 v7, 0
    s_mov_b64 exec, 1
    ds_add_rtn_u32 v6, v7, v6 offset:60
    s_mov_b64 exec, -1
    s_waitcnt lgkmcnt(0)
    v_readfirstlane_b32 s43, v6
    s_cmp_lg_u32 s43, 7
    s_nop 2
    s_cbranch_scc1 RK_77
    s_mov_b32 s60, s24
    s_mov_b32 s61, s25
    s_mov_b32 s62, 8388608
    s_mov_b32 s63, 0x20000
    buffer_load_dwordx2 v[208:209], v158, s[60:63], s84 offen offset:0 nt
    buffer_load_dwordx2 v[210:211], v158, s[60:63], s85 offen offset:0 nt
    buffer_load_dwordx2 v[212:213], v158, s[60:63], s86 offen offset:0 nt
    buffer_load_dwordx2 v[214:215], v158, s[60:63], s87 offen offset:0 nt
    buffer_load_dwordx2 v[216:217], v158, s[60:63], s84 offen offset:2048 nt
    buffer_load_dwordx2 v[218:219], v158, s[60:63], s85 offen offset:2048 nt
    buffer_load_dwordx2 v[220:221], v158, s[60:63], s86 offen offset:2048 nt
    buffer_load_dwordx2 v[222:223], v158, s[60:63], s87 offen offset:2048 nt
    s_setprio 3
RK_77:
    s_cmp_ge_i32 s82, s83
    s_cbranch_scc1 ST_78
    s_call_b64 s[36:37], L_step
ST_78:
    s_add_u32 s83, s83, 1
    s_add_u32 s8, s13, 20480
    buffer_load_dwordx4 v[160:163], v5, s[52:55], s8 offen offset:0 nt
    buffer_load_dwordx4 v[164:167], v5, s[52:55], s8 offen offset:256 nt
    buffer_load_dwordx4 v[168:171], v5, s[52:55], s8 offen offset:2048 nt
    buffer_load_dwordx4 v[172:175], v5, s[52:55], s8 offen offset:2304 nt
    s_cmp_ge_i32 s82, s83
    s_cbranch_scc1 ST_79
    s_call_b64 s[36:37], L_step
ST_79:
    s_add_u32 s83, s83, 1
    s_add_u32 s8, s13, 24576
    buffer_load_dwordx4 v[176:179], v5, s[52:55], s8 offen offset:0 nt
    buffer_load_dwordx4 v[180:183], v5, s[52:55], s8 offen offset:256 nt
    buffer_load_dwordx4 v[184:187], v5, s[52:55], s8 offen offset:2048 nt
    buffer_load_dwordx4 v[188:191], v5, s[52:55], s8 offen offset:2304 nt
    s_cmp_ge_i32 s82, s83
    s_cbranch_scc1 ST_80
    s_call_b64 s[36:37], L_step
ST_80:
    s_add_u32 s83, s83, 1
    s_add_u32 s8, s13, 28672
    buffer_load_dwordx4 v[192:195], v5, s[52:55], s8 offen offset:0 nt
    buffer_load_dwordx4 v[196:199], v5, s[52:55], s8 offen offset:256 nt
    buffer_load_dwordx4 v[200:203], v5, s[52:55], s8 offen offset:2048 nt
    buffer_load_dwordx4 v[204:207], v5, s[52:55], s8 offen offset:2304 nt
    s_branch L_late2
L_part:
    v_mov_b32 v7, 0
    s_mov_b64 exec, 1
    v_mov_b32 v6, 5
    ds_add_u32 v7, v6 offset:232
    v_mov_b32 v6, 1
    ds_add_u32 v7, v6 offset:224
    s_waitcnt vmcnt(16)
    ds_add_u32 v7, v6 offset:228
    s_waitcnt vmcnt(12)
    ds_add_u32 v7, v6 offset:228
    s_waitcnt vmcnt(8)
    ds_add_u32 v7, v6 offset:228
    s_waitcnt vmcnt(4)
    ds_add_u32 v7, v6 offset:228
    s_waitcnt vmcnt(0)
    ds_add_u32 v7, v6 offset:228
    s_mov_b64 exec, -1
HK_81:
    ds_read_b32 v6, v9
    s_waitcnt lgkmcnt(0)
    v_readfirstlane_b32 s7, v6
    s_cmp_lg_u32 s7, 0
    s_nop 2
    s_cbranch_scc1 L_hk
    s_sleep 2
    s_sub_u32 s10, s10, 1
    s_cbranch_scc0 HK_81
    s_mov_b32 s10, 0
L_hk:
    s_cmp_gt_u32 s3, 1
    s_cbranch_scc1 L_qk
    s_lshl_b32 s7, s3, 15
    s_add_u32 s7, s7, 79872
    v_lshl_add_u32 v7, v1, 4, s7
    ds_read_b128 v[128:131], v7 offset:0
    ds_read_b128 v[132:135], v7 offset:1024
    ds_read_b128 v[136:139], v7 offset:2048
    ds_read_b128 v[140:143], v7 offset:3072
    ds_read_b128 v[144:147], v7 offset:4096
    ds_read_b128 v[148:151], v7 offset:5120
    ds_read_b128 v[152:155], v7 offset:6144
    ds_read_b128 v[156:159], v7 offset:7168
    s_waitcnt lgkmcnt(0)
    ds_read_b128 v[160:163], v7 offset:8192
    ds_read_b128 v[164:167], v7 offset:9216
    ds_read_b128 v[168:171], v7 offset:10240
    ds_read_b128 v[172:175], v7 offset:11264
    ds_read_b128 v[176:179], v7 offset:12288
    ds_read_b128 v[180:183], v7 offset:13312
    ds_read_b128 v[184:187], v7 offset:14336
    ds_read_b128 v[188:191], v7 offset:15360
    s_waitcnt lgkmcnt(0)
    ds_read_b128 v[192:195], v7 offset:16384
    ds_read_b128 v[196:199], v7 offset:17408
    ds_read_b128 v[200:203], v7 offset:18432
    ds_read_b128 v[204:207], v7 offset:19456
    ds_read_b128 v[208:211], v7 offset:20480
    ds_read_b128 v[212:215], v7 offset:21504
    ds_read_b128 v[216:219], v7 offset:22528
    ds_read_b128 v[220:223], v7 offset:23552
    s_waitcnt lgkmcnt(0)
    ds_read_b128 v[224:227], v7 offset:24576
    ds_read_b128 v[228:231], v7 offset:25600
    ds_read_b128 v[232:235], v7 offset:26624
    ds_read_b128 v[236:239], v7 offset:27648
    ds_read_b128 v[240:243], v7 offset:28672
    ds_read_b128 v[244:247], v7 offset:29696
    ds_read_b128 v[248:251], v7 offset:30720
    ds_read_b128 v[252:255], v7 offset:31744
    s_waitcnt lgkmcnt(0)
L_qk:
    s_setprio 1
    s_sub_u32 s7, s3, 2
    s_cmp_gt_u32 s7, 1
    s_cbranch_scc1 L_qk2
    s_lshl_b32 s7, s7, 2
    v_mov_b32 v7, s7
    v_mov_b32 v6, 1
    ds_write_b32 v7, v6 offset:24
L_qk2:
    v_and_b32 v6, 7, v3
    v_mul_u32_u24 v7, 272, v6
    v_lshl_add_u32 v7, v2, 5, v7
    v_lshrrev_b32 v8, 3, v3
    v_lshl_add_u32 v7, v8, 4, v7
    ds_read_b128 v[24:27], v7 offset:5120
    ds_read_b128 v[28:31], v7 offset:5248
    s_waitcnt lgkmcnt(0)
    v_mfma_f32_16x16x32_bf16 v[32:35], v[128:131], v[24:27], 0
    v_mfma_f32_16x16x32_bf16 v[36:39], v[136:139], v[24:27], 0
    v_mfma_f32_16x16x32_bf16 v[32:35], v[132:135], v[28:31], v[32:35]
    v_mfma_f32_16x16x32_bf16 v[36:39], v[140:143], v[28:31], v[36:39]
    v_mfma_f32_16x16x32_bf16 v[40:43], v[144:147], v[24:27], 0
    v_mfma_f32_16x16x32_bf16 v[44:47], v[152:155], v[24:27], 0
    v_mfma_f32_16x16x32_bf16 v[40:43], v[148:151], v[28:31], v[40:43]
    v_mfma_f32_16x16x32_bf16 v[44:47], v[156:159], v[28:31], v[44:47]
    s_nop 2
    v_add_f32_dpp v16, v33, v32 row_ror:8 row_mask:0xf bank_mask:0xf
    v_add_f32_dpp v17, v35, v34 row_ror:8 row_mask:0xf bank_mask:0xf
    v_add_f32_dpp v18, v37, v36 row_ror:8 row_mask:0xf bank_mask:0xf
    v_add_f32_dpp v19, v39, v38 row_ror:8 row_mask:0xf bank_mask:0xf
    v_mfma_f32_16x16x32_bf16 v[32:35], v[160:163], v[24:27], 0
    v_mfma_f32_16x16x32_bf16 v[36:39], v[168:171], v[24:27], 0
    v_mfma_f32_16x16x32_bf16 v[32:35], v[164:167], v[28:31], v[32:35]
    v_mfma_f32_16x16x32_bf16 v[36:39], v[172:175], v[28:31], v[36:39]
    v_add_f32_dpp v20, v41, v40 row_ror:8 row_mask:0xf bank_mask:0xf
    v_add_f32_dpp v21, v43, v42 row_ror:8 row_mask:0xf bank_mask:0xf
    v_add_f32_dpp v22, v45, v44 row_ror:8 row_mask:0xf bank_mask:0xf
    v_add_f32_dpp v23, v47, v46 row_ror:8 row_mask:0xf bank_mask:0xf
    v_mfma_f32_16x16x32_bf16 v[40:43], v[176:179], v[24:27], 0
    v_mfma_f32_16x16x32_bf16 v[44:47], v[184:187], v[24:27], 0
    v_mfma_f32_16x16x32_bf16 v[40:43], v[180:183], v[28:31], v[40:43]
    v_mfma_f32_16x16x32_bf16 v[44:47], v[188:191], v[28:31], v[44:47]
    v_add_f32_dpp v128, v33, v32 row_ror:8 row_mask:0xf bank_mask:0xf
    v_add_f32_dpp v129, v35, v34 row_ror:8 row_mask:0xf bank_mask:0xf
    v_add_f32_dpp v130, v37, v36 row_ror:8 row_mask:0xf bank_mask:0xf
    v_add_f32_dpp v131, v39, v38 row_ror:8 row_mask:0xf bank_mask:0xf
    v_mfma_f32_16x16x32_bf16 v[32:35], v[192:195], v[24:27], 0
    v_mfma_f32_16x16x32_bf16 v[36:39], v[200:203], v[24:27], 0
    v_mfma_f32_16x16x32_bf16 v[32:35], v[196:199], v[28:31], v[32:35]
    v_mfma_f32_16x16x32_bf16 v[36:39], v[204:207], v[28:31], v[36:39]
    v_add_f32_dpp v132, v41, v40 row_ror:8 row_mask:0xf bank_mask:0xf
    v_add_f32_dpp v133, v43, v42 row_ror:8 row_mask:0xf bank_mask:0xf
    v_add_f32_dpp v134, v45, v44 row_ror:8 row_mask:0xf bank_mask:0xf
    v_add_f32_dpp v135, v47, v46 row_ror:8 row_mask:0xf bank_mask:0xf
    v_mfma_f32_16x16x32_bf16 v[40:43], v[208:211], v[24:27], 0
    v_mfma_f32_16x16x32_bf16 v[44:47], v[216:219], v[24:27], 0
    v_mfma_f32_16x16x32_bf16 v[40:43], v[212:215], v[28:31], v[40:43]
    v_mfma_f32_16x16x32_bf16 v[44:47], v[220:223], v[28:31], v[44:47]
    v_add_f32_dpp v136, v33, v32 row_ror:8 row_mask:0xf bank_mask:0xf
    v_add_f32_dpp v137, v35, v34 row_ror:8 row_mask:0xf bank_mask:0xf
    v_add_f32_dpp v138, v37, v36 row_ror:8 row_mask:0xf bank_mask:0xf
    v_add_f32_dpp v139, v39, v38 row_ror:8 row_mask:0xf bank_mask:0xf
    v_mfma_f32_16x16x32_bf16 v[32:35], v[224:227], v[24:27], 0
    v_mfma_f32_16x16x32_bf16 v[36:39], v[232:235], v[24:27], 0
    v_mfma_f32_16x16x32_bf16 v[32:35], v[228:231], v[28:31], v[32:35]
    v_mfma_f32_16x16x32_bf16 v[36:39], v[236:239], v[28:31], v[36:39]
    v_add_f32_dpp v140, v41, v40 row_ror:8 row_mask:0xf bank_mask:0xf
    v_add_f32_dpp v141, v43, v42 row_ror:8 row_mask:0xf bank_mask:0xf
    v_add_f32_dpp v142, v45, v44 row_ror:8 row_mask:0xf bank_mask:0xf
    v_add_f32_dpp v143, v47, v46 row_ror:8 row_mask:0xf bank_mask:0xf
    v_mfma_f32_16x16x32_bf16 v[40:43], v[240:243], v[24:27], 0
    v_mfma_f32_16x16x32_bf16 v[44:47], v[248:251], v[24:27], 0
    v_mfma_f32_16x16x32_bf16 v[40:43], v[244:247], v[28:31], v[40:43]
    v_mfma_f32_16x16x32_bf16 v[44:47], v[252:255], v[28:31], v[44:47]
    v_add_f32_dpp v144, v33, v32 row_ror:8 row_mask:0xf bank_mask:0xf
    v_add_f32_dpp v145, v35, v34 row_ror:8 row_mask:0xf bank_mask:0xf
    v_add_f32_dpp v146, v37, v36 row_ror:8 row_mask:0xf bank_mask:0xf
    v_add_f32_dpp v147, v39, v38 row_ror:8 row_mask:0xf bank_mask:0xf
    s_nop 2
    v_add_f32_dpp v148, v41, v40 row_ror:8 row_mask:0xf bank_mask:0xf
    v_add_f32_dpp v149, v43, v42 row_ror:8 row_mask:0xf bank_mask:0xf
    v_add_f32_dpp v150, v45, v44 row_ror:8 row_mask:0xf bank_mask:0xf
    v_add_f32_dpp v151, v47, v46 row_ror:8 row_mask:0xf bank_mask:0xf
    v_cvt_pk_bf16_f32 v16, 0, v16
    v_cvt_pk_bf16_f32 v17, 0, v17
    v_cvt_pk_bf16_f32 v18, 0, v18
    v_cvt_pk_bf16_f32 v19, 0, v19
    v_cvt_pk_bf16_f32 v20, 0, v20
    v_cvt_pk_bf16_f32 v21, 0, v21
    v_cvt_pk_bf16_f32 v22, 0, v22
    v_cvt_pk_bf16_f32 v23, 0, v23
    v_cvt_pk_bf16_f32 v128, 0, v128
    v_cvt_pk_bf16_f32 v129, 0, v129
    v_cvt_pk_bf16_f32 v130, 0, v130
    v_cvt_pk_bf16_f32 v131, 0, v131
    v_cvt_pk_bf16_f32 v132, 0, v132
    v_cvt_pk_bf16_f32 v133, 0, v133
    v_cvt_pk_bf16_f32 v134, 0, v134
    v_cvt_pk_bf16_f32 v135, 0, v135
    v_cvt_pk_bf16_f32 v136, 0, v136
    v_cvt_pk_bf16_f32 v137, 0, v137
    v_cvt_pk_bf16_f32 v138, 0, v138
    v_cvt_pk_bf16_f32 v139, 0, v139
    v_cvt_pk_bf16_f32 v140, 0, v140
    v_cvt_pk_bf16_f32 v141, 0, v141
    v_cvt_pk_bf16_f32 v142, 0, v142
    v_cvt_pk_bf16_f32 v143, 0, v143
    v_cvt_pk_bf16_f32 v144, 0, v144
    v_cvt_pk_bf16_f32 v145, 0, v145
    v_cvt_pk_bf16_f32 v146, 0, v146
    v_cvt_pk_bf16_f32 v147, 0, v147
    v_cvt_pk_bf16_f32 v148, 0, v148
    v_cvt_pk_bf16_f32 v149, 0, v149
    v_cvt_pk_bf16_f32 v150, 0, v150
    v_cvt_pk_bf16_f32 v151, 0, v151
    v_mul_f32 v16, s15, v16
    v_mul_f32 v17, s15, v17
    v_mul_f32 v18, s15, v18
    v_mul_f32 v19, s15, v19
    v_mul_f32 v20, s15, v20
    v_mul_f32 v21, s15, v21
    v_mul_f32 v22, s15, v22
    v_mul_f32 v23, s15, v23
    v_mul_f32 v128, s15, v128
    v_mul_f32 v129, s15, v129
    v_mul_f32 v130, s15, v130
    v_mul_f32 v131, s15, v131
    v_mul_f32 v132, s15, v132
    v_mul_f32 v133, s15, v133
    v_mul_f32 v134, s15, v134
    v_mul_f32 v135, s15, v135
    v_mul_f32 v136, s15, v136
    v_mul_f32 v137, s15, v137
    v_mul_f32 v138, s15, v138
    v_mul_f32 v139, s15, v139
    v_mul_f32 v140, s15, v140
    v_mul_f32 v141, s15, v141
    v_mul_f32 v142, s15, v142
    v_mul_f32 v143, s15, v143
    v_mul_f32 v144, s15, v144
    v_mul_f32 v145, s15, v145
    v_mul_f32 v146, s15, v146
    v_mul_f32 v147, s15, v147
    v_mul_f32 v148, s15, v148
    v_mul_f32 v149, s15, v149
    v_mul_f32 v150, s15, v150
    v_mul_f32 v151, s15, v151
    v_cvt_pk_bf16_f32 v16, 0, v16
    v_cvt_pk_bf16_f32 v17, 0, v17
    v_cvt_pk_bf16_f32 v18, 0, v18
    v_cvt_pk_bf16_f32 v19, 0, v19
    v_cvt_pk_bf16_f32 v20, 0, v20
    v_cvt_pk_bf16_f32 v21, 0, v21
    v_cvt_pk_bf16_f32 v22, 0, v22
    v_cvt_pk_bf16_f32 v23, 0, v23
    v_cvt_pk_bf16_f32 v128, 0, v128
    v_cvt_pk_bf16_f32 v129, 0, v129
    v_cvt_pk_bf16_f32 v130, 0, v130
    v_cvt_pk_bf16_f32 v131, 0, v131
    v_cvt_pk_bf16_f32 v132, 0, v132
    v_cvt_pk_bf16_f32 v133, 0, v133
    v_cvt_pk_bf16_f32 v134, 0, v134
    v_cvt_pk_bf16_f32 v135, 0, v135
    v_cvt_pk_bf16_f32 v136, 0, v136
    v_cvt_pk_bf16_f32 v137, 0, v137
    v_cvt_pk_bf16_f32 v138, 0, v138
    v_cvt_pk_bf16_f32 v139, 0, v139
    v_cvt_pk_bf16_f32 v140, 0, v140
    v_cvt_pk_bf16_f32 v141, 0, v141
    v_cvt_pk_bf16_f32 v142, 0, v142
    v_cvt_pk_bf16_f32 v143, 0, v143
    v_cvt_pk_bf16_f32 v144, 0, v144
    v_cvt_pk_bf16_f32 v145, 0, v145
    v_cvt_pk_bf16_f32 v146, 0, v146
    v_cvt_pk_bf16_f32 v147, 0, v147
    v_cvt_pk_bf16_f32 v148, 0, v148
    v_cvt_pk_bf16_f32 v149, 0, v149
    v_cvt_pk_bf16_f32 v150, 0, v150
    v_cvt_pk_bf16_f32 v151, 0, v151
    v_max3_f32 v12, v16, v17, v18
    v_max3_f32 v12, v12, v19, v20
    v_max3_f32 v12, v12, v21, v22
    v_max3_f32 v12, v12, v23, v128
    v_max3_f32 v12, v12, v129, v130
    v_max3_f32 v12, v12, v131, v132
    v_max3_f32 v12, v12, v133, v134
    v_max3_f32 v12, v12, v135, v136
    v_max3_f32 v12, v12, v137, v138
    v_max3_f32 v12, v12, v139, v140
    v_max3_f32 v12, v12, v141, v142
    v_max3_f32 v12, v12, v143, v144
    v_max3_f32 v12, v12, v145, v146
    v_max3_f32 v12, v12, v147, v148
    v_max3_f32 v12, v12, v149, v150
    v_max_f32 v12, v12, v151
    v_mov_b32 v13, v12
    s_nop 1
    v_permlane16_swap_b32 v12, v13
    v_max_f32 v12, v12, v13
    v_mov_b32 v13, v12
    s_nop 1
    v_permlane32_swap_b32 v12, v13
    v_max_f32 v12, v12, v13
    v_mul_f32 v14, s14, v12
    v_fma_f32 v16, v16, s14, -v14
    v_fma_f32 v17, v17, s14, -v14
    v_fma_f32 v18, v18, s14, -v14
    v_fma_f32 v19, v19, s14, -v14
    v_fma_f32 v20, v20, s14, -v14
    v_fma_f32 v21, v21, s14, -v14
    v_fma_f32 v22, v22, s14, -v14
    v_fma_f32 v23, v23, s14, -v14
    v_fma_f32 v128, v128, s14, -v14
    v_fma_f32 v129, v129, s14, -v14
    v_fma_f32 v130, v130, s14, -v14
    v_fma_f32 v131, v131, s14, -v14
    v_fma_f32 v132, v132, s14, -v14
    v_fma_f32 v133, v133, s14, -v14
    v_fma_f32 v134, v134, s14, -v14
    v_fma_f32 v135, v135, s14, -v14
    v_fma_f32 v136, v136, s14, -v14
    v_fma_f32 v137, v137, s14, -v14
    v_fma_f32 v138, v138, s14, -v14
    v_fma_f32 v139, v139, s14, -v14
    v_fma_f32 v140, v140, s14, -v14
    v_fma_f32 v141, v141, s14, -v14
    v_fma_f32 v142, v142, s14, -v14
    v_fma_f32 v143, v143, s14, -v14
    v_fma_f32 v144, v144, s14, -v14
    v_fma_f32 v145, v145, s14, -v14
    v_fma_f32 v146, v146, s14, -v14
    v_fma_f32 v147, v147, s14, -v14
    v_fma_f32 v148, v148, s14, -v14
    v_fma_f32 v149, v149, s14, -v14
    v_fma_f32 v150, v150, s14, -v14
    v_fma_f32 v151, v151, s14, -v14
    v_exp_f32 v16, v16
    v_exp_f32 v17, v17
    v_exp_f32 v18, v18
    v_exp_f32 v19, v19
    v_exp_f32 v20, v20
    v_exp_f32 v21, v21
    v_exp_f32 v22, v22
    v_exp_f32 v23, v23
    v_exp_f32 v128, v128
    v_exp_f32 v129, v129
    v_exp_f32 v130, v130
    v_exp_f32 v131, v131
    v_exp_f32 v132, v132
    v_exp_f32 v133, v133
    v_exp_f32 v134, v134
    v_exp_f32 v135, v135
    v_exp_f32 v136, v136
    v_exp_f32 v137, v137
    v_exp_f32 v138, v138
    v_exp_f32 v139, v139
    v_exp_f32 v140, v140
    v_exp_f32 v141, v141
    v_exp_f32 v142, v142
    v_exp_f32 v143, v143
    v_exp_f32 v144, v144
    v_exp_f32 v145, v145
    v_exp_f32 v146, v146
    v_exp_f32 v147, v147
    v_exp_f32 v148, v148
    v_exp_f32 v149, v149
    v_exp_f32 v150, v150
    v_exp_f32 v151, v151
    v_add_f32 v13, v16, v17
    v_add_f32 v13, v13, v18
    v_add_f32 v13, v13, v19
    v_add_f32 v13, v13, v20
    v_add_f32 v13, v13, v21
    v_add_f32 v13, v13, v22
    v_add_f32 v13, v13, v23
    v_add_f32 v13, v13, v128
    v_add_f32 v13, v13, v129
    v_add_f32 v13, v13, v130
    v_add_f32 v13, v13, v131
    v_add_f32 v13, v13, v132
    v_add_f32 v13, v13, v133
    v_add_f32 v13, v13, v134
    v_add_f32 v13, v13, v135
    v_add_f32 v13, v13, v136
    v_add_f32 v13, v13, v137
    v_add_f32 v13, v13, v138
    v_add_f32 v13, v13, v139
    v_add_f32 v13, v13, v140
    v_add_f32 v13, v13, v141
    v_add_f32 v13, v13, v142
    v_add_f32 v13, v13, v143
    v_add_f32 v13, v13, v144
    v_add_f32 v13, v13, v145
    v_add_f32 v13, v13, v146
    v_add_f32 v13, v13, v147
    v_add_f32 v13, v13, v148
    v_add_f32 v13, v13, v149
    v_add_f32 v13, v13, v150
    v_add_f32 v13, v13, v151
    v_mov_b32 v14, v13
    s_nop 1
    v_permlane16_swap_b32 v13, v14
    v_add_f32 v13, v13, v14
    v_mov_b32 v14, v13
    s_nop 1
    v_permlane32_swap_b32 v13, v14
    v_add_f32 v13, v13, v14
    s_lshl_b32 s7, s3, 6
    v_lshl_add_u32 v14, v1, 3, s7
    v_mov_b32 v15, 1
    v_mov_b32 v7, 0
    s_mov_b64 exec, 0xff
    ds_write_b64 v14, v[12:13] offset:7424
    s_mov_b64 exec, 1
    ds_add_rtn_u32 v15, v7, v15 offset:8
    s_mov_b64 exec, -1
    s_waitcnt lgkmcnt(0)
    v_readfirstlane_b32 s7, v15
    s_cmp_eq_u32 s7, 7
    s_nop 2
    s_cbranch_scc1 L_mlpub
L_mlback:
    s_add_u32 s4, s5, 1
    s_and_b32 s4, s4, 3
    s_lshl_b32 s4, s4, 1
    s_lshr_b32 s8, s5, 2
    s_add_u32 s4, s4, s8
    s_lshl_b32 s4, s4, 1
    s_and_b32 s8, s6, 1
    s_add_u32 s4, s4, s8
    s_lshr_b32 s9, s4, 2
    s_lshl_b32 s9, s9, 1
    s_lshr_b32 s8, s3, 2
    s_add_u32 s9, s9, s8
    s_lshl_b32 s9, s9, 20
    s_and_b32 s8, s4, 3
    s_lshl_b32 s8, s8, 16
    s_add_u32 s9, s9, s8
    s_and_b32 s8, s3, 3
    s_lshl_b32 s8, s8, 12
    s_add_u32 s9, s9, s8
    s_lshr_b32 s8, s2, 4
    s_lshl_b32 s8, s8, 7
    s_add_u32 s9, s9, s8
    s_add_u32 s84, s9, 0
    s_add_u32 s85, s9, 16384
    s_add_u32 s86, s9, 32768
    s_add_u32 s87, s9, 49152
    v_lshlrev_b32 v158, 18, v2
    v_lshl_add_u32 v158, v3, 3, v158
    s_cmp_eq_u32 s47, 1
    s_cbranch_scc1 L_waitv
    s_cmp_eq_u32 s47, 2
    s_cbranch_scc1 L_tab
    s_setprio 2
    v_mov_b32 v6, 1
    v_mov_b32 v7, 0
    s_mov_b64 exec, 1
    ds_add_rtn_u32 v6, v7, v6 offset:32
    s_mov_b64 exec, -1
    s_waitcnt lgkmcnt(0)
    v_readfirstlane_b32 s27, v6
    s_add_u32 s27, s27, 7
    s_add_u32 s27, s27, s1
    v_mov_b32 v7, 0
AQ_82:
    ds_read_b128 v[40:43], v7 offset:224
    s_waitcnt lgkmcnt(0)
    v_readfirstlane_b32 s7, v40
    s_cmp_ge_u32 s7, s27
    s_cbranch_scc1 AQD_83
    s_sleep 1
    s_sub_u32 s10, s10, 1
    s_cbranch_scc0 AQ_82
    s_mov_b32 s10, 0
AQD_83:
    v_readfirstlane_b32 s82, v41
    v_readfirstlane_b32 s81, v42
    v_readfirstlane_b32 s38, v43
    s_cmp_eq_u32 s42, 0
    s_cselect_b32 s7, 6, 8
    s_cmp_eq_u32 s38, 0
    s_cselect_b32 s38, s7, s38
    s_sub_u32 s83, s81, s38
    s_add_u32 s83, s83, 1
    v_mov_b32 v6, 1
    v_mov_b32 v7, 0
    s_mov_b64 exec, 1
    ds_add_rtn_u32 v6, v7, v6 offset:60
    s_mov_b64 exec, -1
    s_waitcnt lgkmcnt(0)
    v_readfirstlane_b32 s43, v6
    s_cmp_lg_u32 s43, 7
    s_nop 2
    s_cbranch_scc1 RK_84
    s_mov_b32 s60, s24
    s_mov_b32 s61, s25
    s_mov_b32 s62, 8388608
    s_mov_b32 s63, 0x20000
    buffer_load_dwordx2 v[208:209], v158, s[60:63], s84 offen offset:0 nt
    buffer_load_dwordx2 v[210:211], v158, s[60:63], s85 offen offset:0 nt
    buffer_load_dwordx2 v[212:213], v158, s[60:63], s86 offen offset:0 nt
    buffer_load_dwordx2 v[214:215], v158, s[60:63], s87 offen offset:0 nt
    buffer_load_dwordx2 v[216:217], v158, s[60:63], s84 offen offset:2048 nt
    buffer_load_dwordx2 v[218:219], v158, s[60:63], s85 offen offset:2048 nt
    buffer_load_dwordx2 v[220:221], v158, s[60:63], s86 offen offset:2048 nt
    buffer_load_dwordx2 v[222:223], v158, s[60:63], s87 offen offset:2048 nt
    s_setprio 3
RK_84:
    s_cmp_ge_i32 s82, s83
    s_cbranch_scc1 ST_85
    s_call_b64 s[36:37], L_step
ST_85:
    s_add_u32 s83, s83, 1
    s_add_u32 s8, s13, 20480
    buffer_load_dwordx4 v[160:163], v5, s[52:55], s8 offen offset:0 nt
    buffer_load_dwordx4 v[164:167], v5, s[52:55], s8 offen offset:256 nt
    buffer_load_dwordx4 v[168:171], v5, s[52:55], s8 offen offset:2048 nt
    buffer_load_dwordx4 v[172:175], v5, s[52:55], s8 offen offset:2304 nt
    s_cmp_ge_i32 s82, s83
    s_cbranch_scc1 ST_86
    s_call_b64 s[36:37], L_step
ST_86:
    s_add_u32 s83, s83, 1
    s_add_u32 s8, s13, 24576
    buffer_load_dwordx4 v[176:179], v5, s[52:55], s8 offen offset:0 nt
    buffer_load_dwordx4 v[180:183], v5, s[52:55], s8 offen offset:256 nt
    buffer_load_dwordx4 v[184:187], v5, s[52:55], s8 offen offset:2048 nt
    buffer_load_dwordx4 v[188:191], v5, s[52:55], s8 offen offset:2304 nt
    s_cmp_ge_i32 s82, s83
    s_cbranch_scc1 ST_87
    s_call_b64 s[36:37], L_step
ST_87:
    s_add_u32 s83, s83, 1
    s_add_u32 s8, s13, 28672
    buffer_load_dwordx4 v[192:195], v5, s[52:55], s8 offen offset:0 nt
    buffer_load_dwordx4 v[196:199], v5, s[52:55], s8 offen offset:256 nt
    buffer_load_dwordx4 v[200:203], v5, s[52:55], s8 offen offset:2048 nt
    buffer_load_dwordx4 v[204:207], v5, s[52:55], s8 offen offset:2304 nt
L_late2:
    s_mov_b64 exec, 1
    v_mov_b32 v6, 1
    ds_add_u32 v7, v6 offset:20
    s_mov_b64 exec, -1
    s_cmp_eq_u32 s43, 7
    s_cbranch_scc1 L_mlgot
    s_cmp_lt_u32 s43, 6
    s_cbranch_scc1 L_fb
    s_cmp_lg_u32 s0, 1
    s_cbranch_scc1 L_fb
    v_mov_b32 v7, 0
    s_mov_b64 exec, 1
    v_mov_b32 v6, 8
    ds_add_u32 v7, v6 offset:232
    v_mov_b32 v6, 1
    ds_add_u32 v7, v6 offset:224
    s_mov_b64 exec, -1
    s_mov_b32 s0, 3
    s_mov_b64 vcc, 0
    s_branch L_pv1
L_fb:
    s_mul_i32 s8, s43, 4
    s_and_b32 s7, s6, 3
    s_add_u32 s8, s8, s7
    s_mul_i32 s8, s8, 1280
    s_add_u32 s8, s8, 688128
    s_mov_b32 s9, 1
    s_atomic_add s9, s[44:45], s8 glc
    v_mov_b32 v7, 0
    s_mov_b64 exec, 1
    v_mov_b32 v6, 8
    ds_add_u32 v7, v6 offset:232
    v_mov_b32 v6, 1
    ds_add_u32 v7, v6 offset:224
    s_waitcnt vmcnt(28)
    ds_add_u32 v7, v6 offset:228
    s_waitcnt vmcnt(24)
    ds_add_u32 v7, v6 offset:228
    s_waitcnt vmcnt(20)
    ds_add_u32 v7, v6 offset:228
    s_waitcnt vmcnt(16)
    ds_add_u32 v7, v6 offset:228
    s_waitcnt vmcnt(12)
    ds_add_u32 v7, v6 offset:228
    s_waitcnt vmcnt(8)
    ds_add_u32 v7, v6 offset:228
    s_waitcnt vmcnt(4)
    ds_add_u32 v7, v6 offset:228
    s_waitcnt vmcnt(0)
    ds_add_u32 v7, v6 offset:228
    s_mov_b64 exec, -1
    s_waitcnt lgkmcnt(0)
    s_add_u32 s9, s9, 1
    s_mov_b32 s7, 5
    s_cmp_ge_u32 s9, 12
    s_cselect_b32 s7, 5, s7
    s_cmp_ge_u32 s9, 25
    s_cselect_b32 s7, 6, s7
    s_cmp_ge_u32 s9, 38
    s_cselect_b32 s7, 7, s7
    s_cmp_ge_u32 s9, 51
    s_cselect_b32 s7, 9, s7
    v_mov_b32 v8, s7
    ds_write_b32 v7, v8 offset:236
    s_cmp_eq_u32 s43, 0
    s_cbranch_scc1 L_mlget
L_mlgot:
    s_cmp_eq_u32 s0, 1
    s_cbranch_scc1 L_pv
    s_mov_b32 s0, 2
    v_mov_b32 v13, 0
LW_88:
    ds_read_b32 v12, v13 offset:12
    s_waitcnt lgkmcnt(0)
    v_readfirstlane_b32 s7, v12
    s_cmp_ge_u32 s7, 1
    s_cbranch_scc1 LWD_89
    s_sleep 2
    s_sub_u32 s10, s10, 1
    s_cbranch_scc0 LW_88
    s_mov_b32 s10, 0
LWD_89:
    s_nop 4
L_pack:
    v_and_b32 v6, 7, v3
    s_lshl_b32 s7, s3, 5
    v_lshl_add_u32 v14, v6, 2, s7
    ds_read_b32 v12, v14 offset:7936
    s_waitcnt lgkmcnt(0)
    v_mul_f32 v16, v16, v12
    v_mul_f32 v17, v17, v12
    v_mul_f32 v18, v18, v12
    v_mul_f32 v19, v19, v12
    v_mul_f32 v20, v20, v12
    v_mul_f32 v21, v21, v12
    v_mul_f32 v22, v22, v12
    v_mul_f32 v23, v23, v12
    v_mul_f32 v128, v128, v12
    v_mul_f32 v129, v129, v12
    v_mul_f32 v130, v130, v12
    v_mul_f32 v131, v131, v12
    v_mul_f32 v132, v132, v12
    v_mul_f32 v133, v133, v12
    v_mul_f32 v134, v134, v12
    v_mul_f32 v135, v135, v12
    v_mul_f32 v136, v136, v12
    v_mul_f32 v137, v137, v12
    v_mul_f32 v138, v138, v12
    v_mul_f32 v139, v139, v12
    v_mul_f32 v140, v140, v12
    v_mul_f32 v141, v141, v12
    v_mul_f32 v142, v142, v12
    v_mul_f32 v143, v143, v12
    v_mul_f32 v144, v144, v12
    v_mul_f32 v145, v145, v12
    v_mul_f32 v146, v146, v12
    v_mul_f32 v147, v147, v12
    v_mul_f32 v148, v148, v12
    v_mul_f32 v149, v149, v12
    v_mul_f32 v150, v150, v12
    v_mul_f32 v151, v151, v12
    v_cvt_pk_bf16_f32 v16, v16, v17
    v_cvt_pk_bf16_f32 v17, v18, v19
    v_cvt_pk_bf16_f32 v18, v20, v21
    v_cvt_pk_bf16_f32 v19, v22, v23
    v_cvt_pk_bf16_f32 v128, v128, v129
    v_cvt_pk_bf16_f32 v129, v130, v131
    v_cvt_pk_bf16_f32 v130, v132, v133
    v_cvt_pk_bf16_f32 v131, v134, v135
    v_cvt_pk_bf16_f32 v136, v136, v137
    v_cvt_pk_bf16_f32 v137, v138, v139
    v_cvt_pk_bf16_f32 v138, v140, v141
    v_cvt_pk_bf16_f32 v139, v142, v143
    v_cvt_pk_bf16_f32 v144, v144, v145
    v_cvt_pk_bf16_f32 v145, v146, v147
    v_cvt_pk_bf16_f32 v146, v148, v149
    v_cvt_pk_bf16_f32 v147, v150, v151
    s_lshr_b32 s7, s2, 1
    s_cmp_lg_u32 s7, 48
    s_cbranch_scc1 L_nomod
    s_mov_b32 s64, s16
    s_mov_b32 s65, s17
    s_mov_b32 s66, 4096
    s_mov_b32 s67, 0x20000
    v_and_b32 v11, 31, v1
    v_lshlrev_b32 v11, 2, v11
    v_lshrrev_b32 v14, 5, v1
    v_lshl_add_u32 v11, v14, 1, v11
    s_lshl_b32 s7, s3, 7
    v_add_u32 v11, s7, v11
    s_and_b32 s9, s2, 1
    s_mul_i32 s8, s9, 40960
    s_add_u32 s8, s8, 8192
    v_lshl_add_u32 v10, v11, 2, s8
    v_add_u32 v45, 4096, v10
    v_add_u32 v46, 8192, v10
    v_add_u32 v47, 12288, v10
    s_lshl_b32 s9, s9, 11
    v_lshl_add_u32 v11, v11, 1, s9
    buffer_load_dword v44, v11, s[64:67], 0 offen
    buffer_load_dwordx2 v[32:33], v10, s[56:59], 0 offen sc1
    buffer_load_dwordx2 v[34:35], v45, s[56:59], 0 offen sc1
    buffer_load_dwordx2 v[36:37], v46, s[56:59], 0 offen sc1
    buffer_load_dwordx2 v[38:39], v47, s[56:59], 0 offen sc1
L_nomod:
    v_lshlrev_b32 v12, 7, v2
    v_lshl_add_u32 v12, v3, 4, v12
    v_lshlrev_b32 v13, 15, v2
    v_lshrrev_b32 v14, 2, v3
    v_lshl_add_u32 v13, v14, 14, v13
    v_and_b32 v14, 3, v3
    v_lshl_add_u32 v13, v14, 4, v13
    s_and_b32 s7, s5, 3
    s_lshl_b32 s7, s7, 17
    s_lshr_b32 s8, s5, 2
    s_lshl_b32 s8, s8, 6
    s_add_u32 s7, s7, s8
    s_lshl_b32 s8, s6, 7
    s_add_u32 s7, s7, s8
    s_add_u32 s72, s7, 1048576
    s_add_u32 s73, s7, 1052672
    s_add_u32 s74, s7, 1056768
    s_add_u32 s75, s7, 1060864
    v_lshlrev_b32 v159, 4, v1
    s_lshl_b32 s9, s3, 12
    v_add_u32 v156, s9, v159
    v_lshl_add_u32 v155, v3, 6, s9
    v_lshl_add_u32 v155, v2, 4, v155
    s_lshl_b32 s9, s4, 3
    s_add_u32 s9, s9, s3
    s_lshl_b32 s9, s9, 12
    s_add_u32 s80, s9, 1048576
    s_cmp_eq_u32 s0, 0
    s_cselect_b32 s0, 1, s0
    s_cbranch_scc1 L_waitv
L_pv:
    s_cmp_eq_u32 s43, 7
    s_cselect_b64 vcc, -1, 0
    s_cbranch_scc1 L_pv1
    s_setprio 0
L_pv1:
    s_cmp_lg_u32 s0, 3
    s_cbranch_scc1 PR_90
    s_mov_b64 exec, 1
    s_waitcnt vmcnt(28)
    ds_add_u32 v7, v6 offset:228
    s_waitcnt vmcnt(24)
    ds_add_u32 v7, v6 offset:228
    s_mov_b64 exec, -1
PR_90:
    s_waitcnt vmcnt(24)
    v_perm_b32 v24, v52, v48, s11
    v_perm_b32 v25, v60, v56, s11
    v_perm_b32 v26, v68, v64, s11
    v_perm_b32 v27, v76, v72, s11
    v_perm_b32 v28, v52, v48, s12
    v_perm_b32 v29, v60, v56, s12
    v_perm_b32 v30, v68, v64, s12
    v_perm_b32 v31, v76, v72, s12
    v_mfma_f32_16x16x32_bf16 v[224:227], v[24:27], v[16:19], 0
    v_perm_b32 v20, v53, v49, s11
    v_perm_b32 v21, v61, v57, s11
    v_perm_b32 v22, v69, v65, s11
    v_perm_b32 v23, v77, v73, s11
    v_mfma_f32_16x16x32_bf16 v[228:231], v[28:31], v[16:19], 0
    v_perm_b32 v24, v53, v49, s12
    v_perm_b32 v25, v61, v57, s12
    v_perm_b32 v26, v69, v65, s12
    v_perm_b32 v27, v77, v73, s12
    v_mfma_f32_16x16x32_bf16 v[232:235], v[20:23], v[16:19], 0
    v_perm_b32 v28, v54, v50, s11
    v_perm_b32 v29, v62, v58, s11
    v_perm_b32 v30, v70, v66, s11
    v_perm_b32 v31, v78, v74, s11
    v_mfma_f32_16x16x32_bf16 v[236:239], v[24:27], v[16:19], 0
    v_perm_b32 v20, v54, v50, s12
    v_perm_b32 v21, v62, v58, s12
    v_perm_b32 v22, v70, v66, s12
    v_perm_b32 v23, v78, v74, s12
    v_mfma_f32_16x16x32_bf16 v[240:243], v[28:31], v[16:19], 0
    v_perm_b32 v24, v55, v51, s11
    v_perm_b32 v25, v63, v59, s11
    v_perm_b32 v26, v71, v67, s11
    v_perm_b32 v27, v79, v75, s11
    v_mfma_f32_16x16x32_bf16 v[244:247], v[20:23], v[16:19], 0
    v_perm_b32 v28, v55, v51, s12
    v_perm_b32 v29, v63, v59, s12
    v_perm_b32 v30, v71, v67, s12
    v_perm_b32 v31, v79, v75, s12
    v_mfma_f32_16x16x32_bf16 v[248:251], v[24:27], v[16:19], 0
    s_cmp_lg_u32 s0, 3
    s_cbranch_scc1 PR_91
    s_mov_b64 exec, 1
    s_waitcnt vmcnt(20)
    ds_add_u32 v7, v6 offset:228
    s_waitcnt vmcnt(16)
    ds_add_u32 v7, v6 offset:228
    s_mov_b64 exec, -1
PR_91:
    s_waitcnt vmcnt(16)
    v_perm_b32 v20, v84, v80, s11
    v_perm_b32 v21, v92, v88, s11
    v_perm_b32 v22, v100, v96, s11
    v_perm_b32 v23, v108, v104, s11
    v_mfma_f32_16x16x32_bf16 v[252:255], v[28:31], v[16:19], 0
    v_perm_b32 v24, v84, v80, s12
    v_perm_b32 v25, v92, v88, s12
    v_perm_b32 v26, v100, v96, s12
    v_perm_b32 v27, v108, v104, s12
    v_mfma_f32_16x16x32_bf16 v[224:227], v[20:23], v[128:131], v[224:227]
    v_perm_b32 v28, v85, v81, s11
    v_perm_b32 v29, v93, v89, s11
    v_perm_b32 v30, v101, v97, s11
    v_perm_b32 v31, v109, v105, s11
    v_mfma_f32_16x16x32_bf16 v[228:231], v[24:27], v[128:131], v[228:231]
    v_perm_b32 v20, v85, v81, s12
    v_perm_b32 v21, v93, v89, s12
    v_perm_b32 v22, v101, v97, s12
    v_perm_b32 v23, v109, v105, s12
    v_mfma_f32_16x16x32_bf16 v[232:235], v[28:31], v[128:131], v[232:235]
    v_perm_b32 v24, v86, v82, s11
    v_perm_b32 v25, v94, v90, s11
    v_perm_b32 v26, v102, v98, s11
    v_perm_b32 v27, v110, v106, s11
    v_mfma_f32_16x16x32_bf16 v[236:239], v[20:23], v[128:131], v[236:239]
    v_perm_b32 v28, v86, v82, s12
    v_perm_b32 v29, v94, v90, s12
    v_perm_b32 v30, v102, v98, s12
    v_perm_b32 v31, v110, v106, s12
    v_mfma_f32_16x16x32_bf16 v[240:243], v[24:27], v[128:131], v[240:243]
    v_perm_b32 v20, v87, v83, s11
    v_perm_b32 v21, v95, v91, s11
    v_perm_b32 v22, v103, v99, s11
    v_perm_b32 v23, v111, v107, s11
    v_mfma_f32_16x16x32_bf16 v[244:247], v[28:31], v[128:131], v[244:247]
    v_perm_b32 v24, v87, v83, s12
    v_perm_b32 v25, v95, v91, s12
    v_perm_b32 v26, v103, v99, s12
    v_perm_b32 v27, v111, v107, s12
    v_mfma_f32_16x16x32_bf16 v[248:251], v[20:23], v[128:131], v[248:251]
    s_nop 0
    v_mfma_f32_16x16x32_bf16 v[252:255], v[24:27], v[128:131], v[252:255]
    s_cbranch_vccz PV_92
    v_mov_b32 v7, 0
    ds_read_b32 v6, v7 offset:44
    ds_read_b128 v[48:51], v12 offset:1024
    ds_read_b128 v[52:55], v12 offset:1536
    ds_read_b128 v[56:59], v12 offset:2048
    ds_read_b128 v[60:63], v12 offset:2560
    ds_read_b128 v[64:67], v12 offset:3072
    ds_read_b128 v[68:71], v12 offset:3584
    ds_read_b128 v[72:75], v12 offset:4096
    ds_read_b128 v[76:79], v12 offset:4608
    s_waitcnt lgkmcnt(0)
    v_readfirstlane_b32 s9, v6
    s_cmp_lt_u32 s9, 7
    s_cbranch_scc1 PV_93
    v_pk_add_f32 v[224:225], v[224:225], v[48:49]
    v_pk_add_f32 v[226:227], v[226:227], v[50:51]
    v_pk_add_f32 v[228:229], v[228:229], v[52:53]
    v_pk_add_f32 v[230:231], v[230:231], v[54:55]
    v_pk_add_f32 v[232:233], v[232:233], v[56:57]
    v_pk_add_f32 v[234:235], v[234:235], v[58:59]
    v_pk_add_f32 v[236:237], v[236:237], v[60:61]
    v_pk_add_f32 v[238:239], v[238:239], v[62:63]
    v_pk_add_f32 v[240:241], v[240:241], v[64:65]
    v_pk_add_f32 v[242:243], v[242:243], v[66:67]
    v_pk_add_f32 v[244:245], v[244:245], v[68:69]
    v_pk_add_f32 v[246:247], v[246:247], v[70:71]
    v_pk_add_f32 v[248:249], v[248:249], v[72:73]
    v_pk_add_f32 v[250:251], v[250:251], v[74:75]
    v_pk_add_f32 v[252:253], v[252:253], v[76:77]
    v_pk_add_f32 v[254:255], v[254:255], v[78:79]
PV_93:
    s_and_b32 s7, s5, 3
    s_lshl_b32 s7, s7, 5
    s_and_b32 s8, s6, 3
    s_add_u32 s7, s7, s8
    s_mul_i32 s7, s7, 1280
    s_add_u32 s7, s7, 524288
    s_add_u32 s76, s44, s7
    s_addc_u32 s77, s45, 0
    s_mov_b32 s8, 1
    s_waitcnt vmcnt(8)
    s_atomic_add s8, s[76:77], 0
    s_atomic_add s8, s[76:77], 5120
    s_atomic_add s8, s[76:77], 10240
    s_atomic_add s8, s[76:77], 15360
    s_atomic_add s8, s[76:77], 20480
    s_atomic_add s8, s[76:77], 25600
    s_atomic_add s8, s[76:77], 30720
    s_atomic_add s8, s[76:77], 35840
PV_92:
    s_cmp_lg_u32 s0, 3
    s_cbranch_scc1 PR_94
    s_mov_b64 exec, 1
    s_waitcnt vmcnt(12)
    ds_add_u32 v7, v6 offset:228
    s_waitcnt vmcnt(8)
    ds_add_u32 v7, v6 offset:228
    s_mov_b64 exec, -1
PR_94:
    s_waitcnt vmcnt(8)
    v_perm_b32 v28, v116, v112, s11
    v_perm_b32 v29, v124, v120, s11
    v_perm_b32 v30, v164, v160, s11
    v_perm_b32 v31, v172, v168, s11
    v_perm_b32 v20, v116, v112, s12
    v_perm_b32 v21, v124, v120, s12
    v_perm_b32 v22, v164, v160, s12
    v_perm_b32 v23, v172, v168, s12
    v_mfma_f32_16x16x32_bf16 v[224:227], v[28:31], v[136:139], v[224:227]
    v_perm_b32 v24, v117, v113, s11
    v_perm_b32 v25, v125, v121, s11
    v_perm_b32 v26, v165, v161, s11
    v_perm_b32 v27, v173, v169, s11
    v_mfma_f32_16x16x32_bf16 v[228:231], v[20:23], v[136:139], v[228:231]
    v_perm_b32 v28, v117, v113, s12
    v_perm_b32 v29, v125, v121, s12
    v_perm_b32 v30, v165, v161, s12
    v_perm_b32 v31, v173, v169, s12
    v_mfma_f32_16x16x32_bf16 v[232:235], v[24:27], v[136:139], v[232:235]
    v_perm_b32 v20, v118, v114, s11
    v_perm_b32 v21, v126, v122, s11
    v_perm_b32 v22, v166, v162, s11
    v_perm_b32 v23, v174, v170, s11
    v_mfma_f32_16x16x32_bf16 v[236:239], v[28:31], v[136:139], v[236:239]
    v_perm_b32 v24, v118, v114, s12
    v_perm_b32 v25, v126, v122, s12
    v_perm_b32 v26, v166, v162, s12
    v_perm_b32 v27, v174, v170, s12
    v_mfma_f32_16x16x32_bf16 v[240:243], v[20:23], v[136:139], v[240:243]
    v_perm_b32 v28, v119, v115, s11
    v_perm_b32 v29, v127, v123, s11
    v_perm_b32 v30, v167, v163, s11
    v_perm_b32 v31, v175, v171, s11
    v_mfma_f32_16x16x32_bf16 v[244:247], v[24:27], v[136:139], v[244:247]
    v_perm_b32 v20, v119, v115, s12
    v_perm_b32 v21, v127, v123, s12
    v_perm_b32 v22, v167, v163, s12
    v_perm_b32 v23, v175, v171, s12
    v_mfma_f32_16x16x32_bf16 v[248:251], v[28:31], v[136:139], v[248:251]
    s_nop 0
    v_mfma_f32_16x16x32_bf16 v[252:255], v[20:23], v[136:139], v[252:255]
    s_cbranch_vccz PV_95
    s_cmp_ge_u32 s9, 7
    s_cbranch_scc1 PV_96
    v_mov_b32 v7, 0
LW_97:
    ds_read_b32 v6, v7 offset:44
    s_waitcnt lgkmcnt(0)
    v_readfirstlane_b32 s7, v6
    s_cmp_ge_u32 s7, 7
    s_cbranch_scc1 LWD_98
    s_sleep 1
    s_sub_u32 s10, s10, 1
    s_cbranch_scc0 LW_97
    s_mov_b32 s10, 0
LWD_98:
    s_nop 4
    ds_read_b128 v[48:51], v12 offset:1024
    ds_read_b128 v[52:55], v12 offset:1536
    ds_read_b128 v[56:59], v12 offset:2048
    ds_read_b128 v[60:63], v12 offset:2560
    ds_read_b128 v[64:67], v12 offset:3072
    ds_read_b128 v[68:71], v12 offset:3584
    ds_read_b128 v[72:75], v12 offset:4096
    ds_read_b128 v[76:79], v12 offset:4608
    s_waitcnt lgkmcnt(0)
    v_pk_add_f32 v[224:225], v[224:225], v[48:49]
    v_pk_add_f32 v[226:227], v[226:227], v[50:51]
    v_pk_add_f32 v[228:229], v[228:229], v[52:53]
    v_pk_add_f32 v[230:231], v[230:231], v[54:55]
    v_pk_add_f32 v[232:233], v[232:233], v[56:57]
    v_pk_add_f32 v[234:235], v[234:235], v[58:59]
    v_pk_add_f32 v[236:237], v[236:237], v[60:61]
    v_pk_add_f32 v[238:239], v[238:239], v[62:63]
    v_pk_add_f32 v[240:241], v[240:241], v[64:65]
    v_pk_add_f32 v[242:243], v[242:243], v[66:67]
    v_pk_add_f32 v[244:245], v[244:245], v[68:69]
    v_pk_add_f32 v[246:247], v[246:247], v[70:71]
    v_pk_add_f32 v[248:249], v[248:249], v[72:73]
    v_pk_add_f32 v[250:251], v[250:251], v[74:75]
    v_pk_add_f32 v[252:253], v[252:253], v[76:77]
    v_pk_add_f32 v[254:255], v[254:255], v[78:79]
PV_96:
PV_95:
    s_cmp_lg_u32 s0, 3
    s_cbranch_scc1 PR_99
    s_mov_b64 exec, 1
    s_waitcnt vmcnt(4)
    ds_add_u32 v7, v6 offset:228
    s_waitcnt vmcnt(0)
    ds_add_u32 v7, v6 offset:228
    s_mov_b64 exec, -1
PR_99:
    s_waitcnt vmcnt(6)
    v_perm_b32 v80, v180, v176, s11
    v_perm_b32 v84, v180, v176, s12
    v_perm_b32 v88, v181, v177, s11
    v_perm_b32 v92, v181, v177, s12
    v_perm_b32 v96, v182, v178, s11
    v_perm_b32 v100, v182, v178, s12
    v_perm_b32 v104, v183, v179, s11
    v_perm_b32 v108, v183, v179, s12
    s_waitcnt vmcnt(4)
    v_perm_b32 v81, v188, v184, s11
    v_perm_b32 v85, v188, v184, s12
    v_perm_b32 v89, v189, v185, s11
    v_perm_b32 v93, v189, v185, s12
    v_perm_b32 v97, v190, v186, s11
    v_perm_b32 v101, v190, v186, s12
    v_perm_b32 v105, v191, v187, s11
    v_perm_b32 v109, v191, v187, s12
    s_waitcnt vmcnt(2)
    v_perm_b32 v82, v196, v192, s11
    v_perm_b32 v86, v196, v192, s12
    v_perm_b32 v90, v197, v193, s11
    v_perm_b32 v94, v197, v193, s12
    v_perm_b32 v98, v198, v194, s11
    v_perm_b32 v102, v198, v194, s12
    v_perm_b32 v106, v199, v195, s11
    v_perm_b32 v110, v199, v195, s12
    s_waitcnt vmcnt(0)
    v_perm_b32 v83, v204, v200, s11
    v_perm_b32 v87, v204, v200, s12
    v_perm_b32 v91, v205, v201, s11
    v_mfma_f32_16x16x32_bf16 v[224:227], v[80:83], v[144:147], v[224:227]
    v_perm_b32 v95, v205, v201, s12
    v_mfma_f32_16x16x32_bf16 v[228:231], v[84:87], v[144:147], v[228:231]
    v_perm_b32 v99, v206, v202, s11
    v_mfma_f32_16x16x32_bf16 v[232:235], v[88:91], v[144:147], v[232:235]
    v_perm_b32 v103, v206, v202, s12
    v_mfma_f32_16x16x32_bf16 v[236:239], v[92:95], v[144:147], v[236:239]
    v_perm_b32 v107, v207, v203, s11
    v_mfma_f32_16x16x32_bf16 v[240:243], v[96:99], v[144:147], v[240:243]
    v_perm_b32 v111, v207, v203, s12
    v_mfma_f32_16x16x32_bf16 v[244:247], v[100:103], v[144:147], v[244:247]
    v_mfma_f32_16x16x32_bf16 v[248:251], v[104:107], v[144:147], v[248:251]
    v_mfma_f32_16x16x32_bf16 v[252:255], v[108:111], v[144:147], v[252:255]
    s_nop 0
    s_mov_b32 exec_lo, 0x00ff00ff
    s_mov_b32 exec_hi, 0x00ff00ff
    s_cmp_lg_u32 s43, 7
    s_cbranch_scc1 L_accum
    v_cvt_pk_bf16_f32 v48, v224, v225
    v_cvt_pk_bf16_f32 v49, v226, v227
    v_cvt_pk_bf16_f32 v50, v228, v229
    v_cvt_pk_bf16_f32 v51, v230, v231
    v_min_u32 v48, -2, v48
    v_min_u32 v49, -2, v49
    v_min_u32 v50, -2, v50
    v_min_u32 v51, -2, v51
    buffer_store_dwordx4 v[48:51], v13, s[56:59], s72 offen sc1
    v_cvt_pk_bf16_f32 v52, v232, v233
    v_cvt_pk_bf16_f32 v53, v234, v235
    v_cvt_pk_bf16_f32 v54, v236, v237
    v_cvt_pk_bf16_f32 v55, v238, v239
    v_min_u32 v52, -2, v52
    v_min_u32 v53, -2, v53
    v_min_u32 v54, -2, v54
    v_min_u32 v55, -2, v55
    buffer_store_dwordx4 v[52:55], v13, s[56:59], s73 offen sc1
    v_cvt_pk_bf16_f32 v56, v240, v241
    v_cvt_pk_bf16_f32 v57, v242, v243
    v_cvt_pk_bf16_f32 v58, v244, v245
    v_cvt_pk_bf16_f32 v59, v246, v247
    v_min_u32 v56, -2, v56
    v_min_u32 v57, -2, v57
    v_min_u32 v58, -2, v58
    v_min_u32 v59, -2, v59
    buffer_store_dwordx4 v[56:59], v13, s[56:59], s74 offen sc1
    v_cvt_pk_bf16_f32 v60, v248, v249
    v_cvt_pk_bf16_f32 v61, v250, v251
    v_cvt_pk_bf16_f32 v62, v252, v253
    v_cvt_pk_bf16_f32 v63, v254, v255
    v_min_u32 v60, -2, v60
    v_min_u32 v61, -2, v61
    v_min_u32 v62, -2, v62
    v_min_u32 v63, -2, v63
    buffer_store_dwordx4 v[60:63], v13, s[56:59], s75 offen sc1
    s_mov_b64 exec, -1
    s_branch L_b1
L_accum:
    v_mov_b32 v6, 1
    v_mov_b32 v7, 0
    s_mov_b64 exec, 1
    ds_add_rtn_u32 v6, v7, v6 offset:56
    s_mov_b64 exec, -1
    s_waitcnt lgkmcnt(0)
    v_readfirstlane_b32 s8, v6
    v_mov_b32 v7, 0
LW_100:
    ds_read_b32 v6, v7 offset:44
    s_waitcnt lgkmcnt(0)
    v_readfirstlane_b32 s7, v6
    s_cmp_ge_u32 s7, s8
    s_cbranch_scc1 LWD_101
    s_sleep 1
    s_sub_u32 s10, s10, 1
    s_cbranch_scc0 LW_100
    s_mov_b32 s10, 0
LWD_101:
    s_nop 4
    s_mov_b32 exec_lo, 0x00ff00ff
    s_mov_b32 exec_hi, 0x00ff00ff
    ds_read_b128 v[48:51], v12 offset:1024
    ds_read_b128 v[52:55], v12 offset:1536
    ds_read_b128 v[56:59], v12 offset:2048
    ds_read_b128 v[60:63], v12 offset:2560
    ds_read_b128 v[64:67], v12 offset:3072
    ds_read_b128 v[68:71], v12 offset:3584
    ds_read_b128 v[72:75], v12 offset:4096
    ds_read_b128 v[76:79], v12 offset:4608
    s_waitcnt lgkmcnt(0)
    v_pk_add_f32 v[48:49], v[224:225], v[48:49]
    v_pk_add_f32 v[50:51], v[226:227], v[50:51]
    ds_write_b128 v12, v[48:51] offset:1024
    v_pk_add_f32 v[52:53], v[228:229], v[52:53]
    v_pk_add_f32 v[54:55], v[230:231], v[54:55]
    ds_write_b128 v12, v[52:55] offset:1536
    v_pk_add_f32 v[56:57], v[232:233], v[56:57]
    v_pk_add_f32 v[58:59], v[234:235], v[58:59]
    ds_write_b128 v12, v[56:59] offset:2048
    v_pk_add_f32 v[60:61], v[236:237], v[60:61]
    v_pk_add_f32 v[62:63], v[238:239], v[62:63]
    ds_write_b128 v12, v[60:63] offset:2560
    v_pk_add_f32 v[64:65], v[240:241], v[64:65]
    v_pk_add_f32 v[66:67], v[242:243], v[66:67]
    ds_write_b128 v12, v[64:67] offset:3072
    v_pk_add_f32 v[68:69], v[244:245], v[68:69]
    v_pk_add_f32 v[70:71], v[246:247], v[70:71]
    ds_write_b128 v12, v[68:71] offset:3584
    v_pk_add_f32 v[72:73], v[248:249], v[72:73]
    v_pk_add_f32 v[74:75], v[250:251], v[74:75]
    ds_write_b128 v12, v[72:75] offset:4096
    v_pk_add_f32 v[76:77], v[252:253], v[76:77]
    v_pk_add_f32 v[78:79], v[254:255], v[78:79]
    ds_write_b128 v12, v[76:79] offset:4608
    v_mov_b32 v6, 1
    s_mov_b64 exec, 1
    ds_add_u32 v7, v6 offset:44
    s_mov_b64 exec, -1
    s_waitcnt lgkmcnt(0)
    s_lshr_b32 s7, s2, 1
    s_cmp_lg_u32 s7, 48
    s_cbranch_scc1 L_noprep
    s_sub_u32 s9, s43, 1
    s_cmp_gt_u32 s9, 3
    s_cbranch_scc1 L_noprep
    s_lshl_b32 s8, s9, 13
    s_add_u32 s72, s8, 458752
    s_add_u32 s73, s72, 4096
    s_mul_i32 s9, s9, 3072
    v_lshrrev_b32 v14, 3, v1
    v_mul_u32_u24 v14, 48, v14
    v_and_b32 v15, 7, v1
    v_lshl_add_u32 v14, v15, 3, v14
    v_add_u32 v14, s9, v14
    buffer_load_dwordx4 v[160:163], v159, s[56:59], s72 offen offset:0 sc1
    buffer_load_dwordx4 v[164:167], v159, s[56:59], s72 offen offset:1024 sc1
    buffer_load_dwordx4 v[168:171], v159, s[56:59], s72 offen offset:2048 sc1
    buffer_load_dwordx4 v[172:175], v159, s[56:59], s72 offen offset:3072 sc1
    buffer_load_dwordx4 v[176:179], v159, s[56:59], s73 offen offset:0 sc1
    buffer_load_dwordx4 v[180:183], v159, s[56:59], s73 offen offset:1024 sc1
    buffer_load_dwordx4 v[184:187], v159, s[56:59], s73 offen offset:2048 sc1
    buffer_load_dwordx4 v[188:191], v159, s[56:59], s73 offen offset:3072 sc1
    s_waitcnt vmcnt(0)
PT_102:
    v_xor_b32 v16, s26, v161
    v_xor_b32 v17, s26, v163
    v_or_b32 v16, v16, v17
    v_xor_b32 v17, s26, v165
    v_or_b32 v16, v16, v17
    v_xor_b32 v17, s26, v167
    v_or_b32 v16, v16, v17
    v_xor_b32 v17, s26, v169
    v_or_b32 v16, v16, v17
    v_xor_b32 v17, s26, v171
    v_or_b32 v16, v16, v17
    v_xor_b32 v17, s26, v173
    v_or_b32 v16, v16, v17
    v_xor_b32 v17, s26, v175
    v_or_b32 v16, v16, v17
    v_xor_b32 v17, s26, v177
    v_or_b32 v16, v16, v17
    v_xor_b32 v17, s26, v179
    v_or_b32 v16, v16, v17
    v_xor_b32 v17, s26, v181
    v_or_b32 v16, v16, v17
    v_xor_b32 v17, s26, v183
    v_or_b32 v16, v16, v17
    v_xor_b32 v17, s26, v185
    v_or_b32 v16, v16, v17
    v_xor_b32 v17, s26, v187
    v_or_b32 v16, v16, v17
    v_xor_b32 v17, s26, v189
    v_or_b32 v16, v16, v17
    v_xor_b32 v17, s26, v191
    v_or_b32 v16, v16, v17
    v_cmp_ne_u32 vcc, 0, v16
    s_cbranch_vccz PTD_103
    s_sleep 8
    buffer_load_dwordx4 v[160:163], v159, s[56:59], s72 offen offset:0 sc1
    buffer_load_dwordx4 v[164:167], v159, s[56:59], s72 offen offset:1024 sc1
    buffer_load_dwordx4 v[168:171], v159, s[56:59], s72 offen offset:2048 sc1
    buffer_load_dwordx4 v[172:175], v159, s[56:59], s72 offen offset:3072 sc1
    buffer_load_dwordx4 v[176:179], v159, s[56:59], s73 offen offset:0 sc1
    buffer_load_dwordx4 v[180:183], v159, s[56:59], s73 offen offset:1024 sc1
    buffer_load_dwordx4 v[184:187], v159, s[56:59], s73 offen offset:2048 sc1
    buffer_load_dwordx4 v[188:191], v159, s[56:59], s73 offen offset:3072 sc1
    s_waitcnt vmcnt(0)
    s_sub_u32 s10, s10, 1
    s_cbranch_scc0 PT_102
    s_mov_b32 s10, 0
PTD_103:
    s_mov_b32 exec_lo, 0x3f3f3f3f
    s_mov_b32 exec_hi, 0x3f3f3f3f
    v_mov_b32 v161, v162
    ds_write_b64 v14, v[160:161] offset:8192
    v_mov_b32 v165, v166
    ds_write_b64 v14, v[164:165] offset:8576
    v_mov_b32 v169, v170
    ds_write_b64 v14, v[168:169] offset:8960
    v_mov_b32 v173, v174
    ds_write_b64 v14, v[172:173] offset:9344
    v_mov_b32 v177, v178
    ds_write_b64 v14, v[176:177] offset:9728
    v_mov_b32 v181, v182
    ds_write_b64 v14, v[180:181] offset:10112
    v_mov_b32 v185, v186
    ds_write_b64 v14, v[184:185] offset:10496
    v_mov_b32 v189, v190
    ds_write_b64 v14, v[188:189] offset:10880
    s_mov_b64 exec, -1
L_noprep:
    v_mov_b32 v7, 0
LW_104:
    ds_read_b32 v6, v7 offset:20
    s_waitcnt lgkmcnt(0)
    v_readfirstlane_b32 s7, v6
    s_cmp_ge_u32 s7, 8
    s_cbranch_scc1 LWD_105
    s_sleep 1
    s_sub_u32 s10, s10, 1
    s_cbranch_scc0 LW_104
    s_mov_b32 s10, 0
LWD_105:
    s_nop 4
L_wonow:
    s_mov_b32 s60, s24
    s_mov_b32 s61, s25
    s_mov_b32 s62, 8388608
    s_mov_b32 s63, 0x20000
    buffer_load_dwordx2 v[208:209], v158, s[60:63], s84 offen offset:0 nt
    buffer_load_dwordx2 v[210:211], v158, s[60:63], s85 offen offset:0 nt
    buffer_load_dwordx2 v[212:213], v158, s[60:63], s86 offen offset:0 nt
    buffer_load_dwordx2 v[214:215], v158, s[60:63], s87 offen offset:0 nt
    buffer_load_dwordx2 v[216:217], v158, s[60:63], s84 offen offset:2048 nt
    buffer_load_dwordx2 v[218:219], v158, s[60:63], s85 offen offset:2048 nt
    buffer_load_dwordx2 v[220:221], v158, s[60:63], s86 offen offset:2048 nt
    buffer_load_dwordx2 v[222:223], v158, s[60:63], s87 offen offset:2048 nt
    s_cmp_lg_u32 s43, 0
    s_cbranch_scc1 G1D_107
    s_setprio 3
    s_lshr_b32 s7, s4, 2
    s_lshl_b32 s7, s7, 3
    s_and_b32 s8, s6, 7
    s_add_u32 s7, s7, s8
    s_mul_i32 s7, s7, 5120
    s_add_u32 s7, s7, 524288
    s_add_u32 s76, s44, s7
    s_addc_u32 s77, s45, 0
G1_106:
    s_load_dword s72, s[76:77], 0 glc
    s_load_dword s73, s[76:77], 1280 glc
    s_load_dword s74, s[76:77], 2560 glc
    s_load_dword s75, s[76:77], 3840 glc
    s_waitcnt lgkmcnt(0)
    s_add_u32 s72, s72, s73
    s_add_u32 s74, s74, s75
    s_add_u32 s72, s72, s74
    s_cmp_ge_i32 s72, 60
    s_cbranch_scc1 G1D_107
    s_sub_u32 s10, s10, 1
    s_cbranch_scc0 G1_106
    s_mov_b32 s10, 0
G1D_107:
L_b1:
    s_mov_b32 s47, 0
    s_barrier
    buffer_load_dwordx4 v[96:99], v159, s[56:59], s80 offen offset:0 sc1
    buffer_load_dwordx4 v[100:103], v159, s[56:59], s80 offen offset:1024 sc1
    buffer_load_dwordx4 v[104:107], v159, s[56:59], s80 offen offset:2048 sc1
    buffer_load_dwordx4 v[108:111], v159, s[56:59], s80 offen offset:3072 sc1
    s_waitcnt vmcnt(4) lgkmcnt(0)
    v_mov_b32 v80, 0
    v_mov_b32 v81, 0
    v_mov_b32 v82, 0
    v_mov_b32 v83, 0
    v_mov_b32 v84, 0
    v_mov_b32 v85, 0
    v_mov_b32 v86, 0
    v_mov_b32 v87, 0
    v_mov_b32 v88, 0
    v_mov_b32 v89, 0
    v_mov_b32 v90, 0
    v_mov_b32 v91, 0
    v_mov_b32 v92, 0
    v_mov_b32 v93, 0
    v_mov_b32 v94, 0
    v_mov_b32 v95, 0
    v_perm_b32 v112, v210, v208, s11
    v_perm_b32 v113, v214, v212, s11
    v_perm_b32 v114, v218, v216, s11
    v_perm_b32 v115, v222, v220, s11
    v_perm_b32 v116, v210, v208, s12
    v_perm_b32 v117, v214, v212, s12
    v_perm_b32 v118, v218, v216, s12
    v_perm_b32 v119, v222, v220, s12
    v_perm_b32 v120, v211, v209, s11
    v_perm_b32 v121, v215, v213, s11
    v_perm_b32 v122, v219, v217, s11
    v_perm_b32 v123, v223, v221, s11
    v_perm_b32 v124, v211, v209, s12
    v_perm_b32 v125, v215, v213, s12
    v_perm_b32 v126, v219, v217, s12
    v_perm_b32 v127, v223, v221, s12
    s_lshr_b32 s7, s2, 1
    s_cmp_lg_u32 s7, 48
    s_cbranch_scc1 L_noprep2
PT_108:
    v_xor_b32 v16, s26, v33
    v_xor_b32 v17, s26, v35
    v_or_b32 v16, v16, v17
    v_xor_b32 v17, s26, v37
    v_or_b32 v16, v16, v17
    v_xor_b32 v17, s26, v39
    v_or_b32 v16, v16, v17
    v_cmp_ne_u32 vcc, 0, v16
    s_cbranch_vccz PTD_109
    s_sleep 8
    buffer_load_dwordx2 v[32:33], v10, s[56:59], 0 offen sc1
    buffer_load_dwordx2 v[34:35], v45, s[56:59], 0 offen sc1
    buffer_load_dwordx2 v[36:37], v46, s[56:59], 0 offen sc1
    buffer_load_dwordx2 v[38:39], v47, s[56:59], 0 offen sc1
    s_waitcnt vmcnt(0)
    s_sub_u32 s10, s10, 1
    s_cbranch_scc0 PT_108
    s_mov_b32 s10, 0
PTD_109:
    v_lshlrev_b32 v176, 16, v32
    v_and_b32 v177, 0xffff0000, v32
    v_lshlrev_b32 v178, 16, v34
    v_and_b32 v179, 0xffff0000, v34
    v_lshlrev_b32 v180, 16, v36
    v_and_b32 v181, 0xffff0000, v36
    v_lshlrev_b32 v182, 16, v38
    v_and_b32 v183, 0xffff0000, v38
    v_lshlrev_b32 v184, 16, v44
    v_and_b32 v185, 0xffff0000, v44
    v_add_f32 v180, 1.0, v180
    v_add_f32 v181, 1.0, v181
    v_lshlrev_b32 v5, 3, v2
    v_cvt_pk_bf16_f32 v180, 0, v180
    v_cvt_pk_bf16_f32 v181, 0, v181
    v_add_f32 v16, v180, v181
    v_mul_f32 v17, v180, v180
    v_fmac_f32 v17, v181, v181
    v_mul_f32 v18, v180, v178
    v_fmac_f32 v18, v181, v179
    v_add_f32 v19, v178, v179
    v_mul_f32 v20, v178, v178
    v_fmac_f32 v20, v179, v179
    v_mov_b32 v21, 0
    v_mov_b32 v22, 0
    v_mov_b32 v23, 0
    v_permlane32_swap_b32 v16, v20
    v_permlane32_swap_b32 v17, v21
    v_permlane32_swap_b32 v18, v22
    v_permlane32_swap_b32 v19, v23
    v_add_f32 v16, v16, v20
    v_add_f32 v17, v17, v21
    v_add_f32 v18, v18, v22
    v_add_f32 v19, v19, v23
    s_nop 0
    v_permlane16_swap_b32 v16, v18
    v_permlane16_swap_b32 v17, v19
    v_add_f32 v16, v16, v18
    v_add_f32 v17, v17, v19
    s_nop 0
    v_add_f32_dpp v16, v16, v16 row_ror:8 row_mask:0xf bank_mask:0xf
    v_add_f32_dpp v17, v17, v17 row_ror:8 row_mask:0xf bank_mask:0xf
    s_nop 0
    v_add_f32_dpp v16, v16, v16 row_ror:4 row_mask:0xf bank_mask:0xf
    v_add_f32_dpp v17, v17, v17 row_ror:4 row_mask:0xf bank_mask:0xf
    s_nop 0
    v_add_f32_dpp v16, v16, v16 row_ror:2 row_mask:0xf bank_mask:0xf
    v_add_f32_dpp v17, v17, v17 row_ror:2 row_mask:0xf bank_mask:0xf
    s_nop 0
    v_add_f32_dpp v16, v16, v16 row_ror:1 row_mask:0xf bank_mask:0xf
    v_add_f32_dpp v17, v17, v17 row_ror:1 row_mask:0xf bank_mask:0xf
    s_mov_b32 exec_lo, 0x00010001
    s_mov_b32 exec_hi, 0x00010001
    ds_add_f32 v5, v16 offset:96
    ds_add_f32 v5, v17 offset:100
    s_mov_b64 exec, -1
L_noprep2:
    v_lshlrev_b32 v15, 3, v1
    s_lshl_b32 s7, s3, 9
    v_lshrrev_b32 v9, 5, v1
    v_lshl_add_u32 v14, v9, 8, s7
    v_lshl_add_u32 v14, v3, 4, v14
    v_and_b32 v13, 1, v2
    v_lshl_add_u32 v14, v13, 3, v14
    v_mov_b32 v6, 1
    v_mov_b32 v7, 0
H1_110:
    s_waitcnt vmcnt(3)
    ds_write_b128 v156, v[96:99] offset:32768
    ds_read_b128 v[128:131], v155 offset:32768
    v_max3_u32 v16, v96, v97, v98
    v_max_u32 v16, v16, v99
    v_cmp_eq_u32 s[72:73], -1, v16
    s_waitcnt vmcnt(2)
    ds_write_b128 v156, v[100:103] offset:33792
    ds_read_b128 v[132:135], v155 offset:33792
    v_max3_u32 v17, v100, v101, v102
    v_max_u32 v17, v17, v103
    v_cmp_eq_u32 s[74:75], -1, v17
    s_waitcnt lgkmcnt(2)
    s_bitcmp1_b32 s47, 0
    s_cbranch_scc1 HK_112
    s_cmp_lg_u64 s[72:73], 0
    s_cbranch_scc1 HK_112
    v_mfma_f32_16x16x32_bf16 v[80:83], v[128:131], v[112:115], v[80:83]
    v_mfma_f32_16x16x32_bf16 v[84:87], v[128:131], v[116:119], v[84:87]
    v_mfma_f32_16x16x32_bf16 v[88:91], v[128:131], v[120:123], v[88:91]
    v_mfma_f32_16x16x32_bf16 v[92:95], v[128:131], v[124:127], v[92:95]
    s_bitset1_b32 s47, 0
HK_112:
    s_waitcnt vmcnt(1)
    ds_write_b128 v156, v[104:107] offset:34816
    ds_read_b128 v[136:139], v155 offset:34816
    v_max3_u32 v18, v104, v105, v106
    v_max_u32 v18, v18, v107
    v_cmp_eq_u32 s[76:77], -1, v18
    s_waitcnt lgkmcnt(2)
    s_bitcmp1_b32 s47, 1
    s_cbranch_scc1 HK_113
    s_cmp_lg_u64 s[74:75], 0
    s_cbranch_scc1 HK_113
    v_mfma_f32_16x16x32_bf16 v[80:83], v[132:135], v[112:115], v[80:83]
    v_mfma_f32_16x16x32_bf16 v[84:87], v[132:135], v[116:119], v[84:87]
    v_mfma_f32_16x16x32_bf16 v[88:91], v[132:135], v[120:123], v[88:91]
    v_mfma_f32_16x16x32_bf16 v[92:95], v[132:135], v[124:127], v[92:95]
    s_bitset1_b32 s47, 1
HK_113:
    s_waitcnt vmcnt(0)
    ds_write_b128 v156, v[108:111] offset:35840
    ds_read_b128 v[140:143], v155 offset:35840
    v_max3_u32 v19, v108, v109, v110
    v_max_u32 v19, v19, v111
    v_cmp_eq_u32 s[78:79], -1, v19
    s_waitcnt lgkmcnt(2)
    s_bitcmp1_b32 s47, 2
    s_cbranch_scc1 HK_114
    s_cmp_lg_u64 s[76:77], 0
    s_cbranch_scc1 HK_114
    v_mfma_f32_16x16x32_bf16 v[80:83], v[136:139], v[112:115], v[80:83]
    v_mfma_f32_16x16x32_bf16 v[84:87], v[136:139], v[116:119], v[84:87]
    v_mfma_f32_16x16x32_bf16 v[88:91], v[136:139], v[120:123], v[88:91]
    v_mfma_f32_16x16x32_bf16 v[92:95], v[136:139], v[124:127], v[92:95]
    s_bitset1_b32 s47, 2
HK_114:
    s_waitcnt lgkmcnt(0)
    s_bitcmp1_b32 s47, 3
    s_cbranch_scc1 HK_115
    s_cmp_lg_u64 s[78:79], 0
    s_cbranch_scc1 HK_115
    v_mfma_f32_16x16x32_bf16 v[80:83], v[140:143], v[112:115], v[80:83]
    v_mfma_f32_16x16x32_bf16 v[84:87], v[140:143], v[116:119], v[84:87]
    v_mfma_f32_16x16x32_bf16 v[88:91], v[140:143], v[120:123], v[88:91]
    v_mfma_f32_16x16x32_bf16 v[92:95], v[140:143], v[124:127], v[92:95]
    s_bitset1_b32 s47, 3
HK_115:
    s_cmp_eq_u32 s47, 15
    s_cbranch_scc1 H1D_111
    s_mov_b64 exec, s[72:73]
    s_cbranch_execz HR_116
    buffer_load_dwordx4 v[96:99], v159, s[56:59], s80 offen offset:0 sc1
HR_116:
    s_mov_b64 exec, s[74:75]
    s_cbranch_execz HR_117
    buffer_load_dwordx4 v[100:103], v159, s[56:59], s80 offen offset:1024 sc1
HR_117:
    s_mov_b64 exec, s[76:77]
    s_cbranch_execz HR_118
    buffer_load_dwordx4 v[104:107], v159, s[56:59], s80 offen offset:2048 sc1
HR_118:
    s_mov_b64 exec, s[78:79]
    s_cbranch_execz HR_119
    buffer_load_dwordx4 v[108:111], v159, s[56:59], s80 offen offset:3072 sc1
HR_119:
    s_mov_b64 exec, -1
    s_waitcnt vmcnt(0)
    s_sub_u32 s10, s10, 1
    s_cbranch_scc0 H1_110
    s_mov_b32 s10, 0
H1D_111:
    s_nop 5
    v_pk_add_f32 v[80:81], v[80:81], v[82:83]
    v_pk_add_f32 v[84:85], v[84:85], v[86:87]
    v_pk_add_f32 v[88:89], v[88:89], v[90:91]
    v_pk_add_f32 v[92:93], v[92:93], v[94:95]
    v_permlane32_swap_b32 v80, v81
    v_permlane32_swap_b32 v84, v85
    v_permlane32_swap_b32 v88, v89
    v_permlane32_swap_b32 v92, v93
    v_add_f32 v48, v80, v81
    v_add_f32 v49, v84, v85
    v_add_f32 v50, v88, v89
    v_add_f32 v51, v92, v93
    s_nop 0
    v_permlane16_swap_b32 v48, v50
    v_permlane16_swap_b32 v49, v51
    v_pk_add_f32 v[48:49], v[48:49], v[50:51]
    ds_write_b64 v14, v[48:49] offset:24576
    s_mov_b64 exec, 1
    ds_add_rtn_u32 v16, v7, v6 offset:48
    s_mov_b64 exec, -1
    ds_read_b64 v[64:65], v15 offset:24576
    ds_read_b64 v[66:67], v15 offset:25088
    ds_read_b64 v[68:69], v15 offset:25600
    ds_read_b64 v[70:71], v15 offset:26112
    ds_read_b64 v[72:73], v15 offset:26624
    ds_read_b64 v[74:75], v15 offset:27136
    ds_read_b64 v[76:77], v15 offset:27648
    ds_read_b64 v[78:79], v15 offset:28160
    v_lshlrev_b32 v12, 15, v9
    v_lshlrev_b32 v9, 16, v9
    v_and_b32 v13, 31, v1
    v_lshl_add_u32 v9, v13, 3, v9
    s_lshl_b32 s7, s4, 12
    s_lshr_b32 s8, s2, 4
    s_lshl_b32 s8, s8, 8
    s_add_u32 s7, s7, s8
    s_add_u32 s8, s7, 1572864
    s_waitcnt lgkmcnt(0)
    v_readfirstlane_b32 s7, v16
    v_pk_add_f32 v[64:65], v[64:65], v[66:67]
    v_pk_add_f32 v[68:69], v[68:69], v[70:71]
    v_pk_add_f32 v[72:73], v[72:73], v[74:75]
    v_pk_add_f32 v[76:77], v[76:77], v[78:79]
    v_pk_add_f32 v[64:65], v[64:65], v[68:69]
    v_pk_add_f32 v[72:73], v[72:73], v[76:77]
    v_pk_add_f32 v[64:65], v[64:65], v[72:73]
    s_cmp_lg_u32 s7, 7
    s_cbranch_scc1 L_nopub2
    v_min_u32 v64, -2, v64
    v_min_u32 v65, -2, v65
    buffer_store_dwordx2 v[64:65], v9, s[56:59], s8 offen sc1
L_nopub2:
    s_lshr_b32 s7, s2, 1
    s_cmp_lg_u32 s7, 48
    s_cbranch_scc1 L_fin
    v_lshl_add_u32 v12, v13, 4, v12
    s_and_b32 s9, s2, 1
    s_lshl_b32 s9, s9, 16
    s_lshl_b32 s8, s3, 9
    s_add_u32 s9, s9, s8
    s_add_u32 s9, s9, 1572864
    v_add_u32 v112, 0, v12
    v_add_u32 v113, 4096, v12
    v_add_u32 v114, 8192, v12
    v_add_u32 v115, 12288, v12
    v_add_u32 v116, 16384, v12
    v_add_u32 v117, 20480, v12
    v_add_u32 v118, 24576, v12
    v_add_u32 v119, 28672, v12
    s_barrier
    buffer_load_dwordx4 v[64:67], v112, s[56:59], s9 offen sc1
    buffer_load_dwordx4 v[68:71], v113, s[56:59], s9 offen sc1
    buffer_load_dwordx4 v[72:75], v114, s[56:59], s9 offen sc1
    buffer_load_dwordx4 v[76:79], v115, s[56:59], s9 offen sc1
    buffer_load_dwordx4 v[80:83], v116, s[56:59], s9 offen sc1
    buffer_load_dwordx4 v[84:87], v117, s[56:59], s9 offen sc1
    buffer_load_dwordx4 v[88:91], v118, s[56:59], s9 offen sc1
    buffer_load_dwordx4 v[92:95], v119, s[56:59], s9 offen sc1
    s_mov_b32 s64, s40
    s_mov_b32 s65, s41
    s_mov_b32 s66, 4096
    s_mov_b32 s67, 0x20000
    ds_read_b128 v[100:103], v7 offset:96
    ds_read_b32 v104, v7 offset:112
    v_mov_b32 v105, 13824
    v_mov_b32 v106, 3072
    v_mov_b32 v107, 0x3727c5ac
    s_waitcnt lgkmcnt(0)
    v_mul_f32 v100, 0x3a800000, v100
    v_mul_f32 v101, 0x3a800000, v101
    v_mul_f32 v102, 0x3a800000, v102
    v_mul_f32 v103, 0x3a800000, v103
    v_mul_f32 v104, 0x3a800000, v104
PM_120:
    s_waitcnt vmcnt(0)
    v_max3_u32 v16, v64, v65, v66
    v_max_u32 v16, v16, v67
    v_max3_u32 v17, v68, v69, v70
    v_max_u32 v17, v17, v71
    v_max3_u32 v18, v72, v73, v74
    v_max_u32 v18, v18, v75
    v_max3_u32 v19, v76, v77, v78
    v_max_u32 v19, v19, v79
    v_max3_u32 v20, v80, v81, v82
    v_max_u32 v20, v20, v83
    v_max3_u32 v21, v84, v85, v86
    v_max_u32 v21, v21, v87
    v_max3_u32 v22, v88, v89, v90
    v_max_u32 v22, v22, v91
    v_max3_u32 v23, v92, v93, v94
    v_max_u32 v23, v23, v95
    v_cmp_eq_u32 s[72:73], -1, v16
    v_cmp_eq_u32 s[74:75], -1, v17
    v_cmp_eq_u32 s[76:77], -1, v18
    v_cmp_eq_u32 s[78:79], -1, v19
    v_cmp_eq_u32 s[80:81], -1, v20
    v_cmp_eq_u32 s[82:83], -1, v21
    v_cmp_eq_u32 s[84:85], -1, v22
    v_cmp_eq_u32 s[86:87], -1, v23
    s_or_b64 vcc, s[72:73], s[74:75]
    s_or_b64 vcc, vcc, s[76:77]
    s_or_b64 vcc, vcc, s[78:79]
    s_or_b64 vcc, vcc, s[80:81]
    s_or_b64 vcc, vcc, s[82:83]
    s_or_b64 vcc, vcc, s[84:85]
    s_or_b64 vcc, vcc, s[86:87]
    s_cbranch_scc0 PMD_121
    s_mov_b64 exec, s[72:73]
    s_cbranch_execz PK_122
    buffer_load_dwordx4 v[64:67], v112, s[56:59], s9 offen sc1
PK_122:
    s_mov_b64 exec, s[74:75]
    s_cbranch_execz PK_123
    buffer_load_dwordx4 v[68:71], v113, s[56:59], s9 offen sc1
PK_123:
    s_mov_b64 exec, s[76:77]
    s_cbranch_execz PK_124
    buffer_load_dwordx4 v[72:75], v114, s[56:59], s9 offen sc1
PK_124:
    s_mov_b64 exec, s[78:79]
    s_cbranch_execz PK_125
    buffer_load_dwordx4 v[76:79], v115, s[56:59], s9 offen sc1
PK_125:
    s_mov_b64 exec, s[80:81]
    s_cbranch_execz PK_126
    buffer_load_dwordx4 v[80:83], v116, s[56:59], s9 offen sc1
PK_126:
    s_mov_b64 exec, s[82:83]
    s_cbranch_execz PK_127
    buffer_load_dwordx4 v[84:87], v117, s[56:59], s9 offen sc1
PK_127:
    s_mov_b64 exec, s[84:85]
    s_cbranch_execz PK_128
    buffer_load_dwordx4 v[88:91], v118, s[56:59], s9 offen sc1
PK_128:
    s_mov_b64 exec, s[86:87]
    s_cbranch_execz PK_129
    buffer_load_dwordx4 v[92:95], v119, s[56:59], s9 offen sc1
PK_129:
    s_mov_b64 exec, -1
    s_sub_u32 s10, s10, 1
    s_cbranch_scc0 PM_120
    s_mov_b32 s10, 0
    s_waitcnt vmcnt(0)
PMD_121:
    v_pk_add_f32 v[64:65], v[64:65], v[68:69]
    v_pk_add_f32 v[66:67], v[66:67], v[70:71]
    v_pk_add_f32 v[72:73], v[72:73], v[76:77]
    v_pk_add_f32 v[74:75], v[74:75], v[78:79]
    v_pk_add_f32 v[80:81], v[80:81], v[84:85]
    v_pk_add_f32 v[82:83], v[82:83], v[86:87]
    v_pk_add_f32 v[88:89], v[88:89], v[92:93]
    v_pk_add_f32 v[90:91], v[90:91], v[94:95]
    v_pk_add_f32 v[64:65], v[64:65], v[72:73]
    v_pk_add_f32 v[66:67], v[66:67], v[74:75]
    v_pk_add_f32 v[80:81], v[80:81], v[88:89]
    v_pk_add_f32 v[82:83], v[82:83], v[90:91]
    v_pk_add_f32 v[64:65], v[64:65], v[80:81]
    v_pk_add_f32 v[66:67], v[66:67], v[82:83]
    s_nop 1
    v_permlane32_swap_b32 v64, v66
    v_permlane32_swap_b32 v65, v67
    v_pk_add_f32 v[64:65], v[64:65], v[66:67]
    v_pk_fma_f32 v[64:65], v[64:65], v[176:177], v[184:185]
    v_pk_mul_f32 v[66:67], v[64:65], v[180:181]
    v_add_f32 v68, v64, v65
    v_mul_f32 v69, v64, v64
    v_mul_f32 v72, v66, v180
    v_mul_f32 v73, v66, v178
    v_mul_f32 v71, v66, v66
    v_fmac_f32 v69, v65, v65
    v_fmac_f32 v72, v67, v181
    v_fmac_f32 v73, v67, v179
    v_add_f32 v70, v66, v67
    v_fmac_f32 v71, v67, v67
    v_permlane32_swap_b32 v68, v72
    v_permlane32_swap_b32 v69, v73
    v_add_f32 v68, v68, v72
    v_add_f32 v69, v69, v73
    s_nop 0
    v_permlane16_swap_b32 v68, v70
    v_permlane16_swap_b32 v69, v71
    v_add_f32 v68, v68, v70
    v_add_f32 v69, v69, v71
    s_nop 0
    v_add_f32_dpp v68, v68, v68 row_ror:8 row_mask:0xf bank_mask:0xf
    v_add_f32_dpp v69, v69, v69 row_ror:8 row_mask:0xf bank_mask:0xf
    s_nop 0
    v_add_f32_dpp v68, v68, v68 row_ror:4 row_mask:0xf bank_mask:0xf
    v_add_f32_dpp v69, v69, v69 row_ror:4 row_mask:0xf bank_mask:0xf
    s_nop 0
    v_add_f32_dpp v68, v68, v68 row_ror:2 row_mask:0xf bank_mask:0xf
    v_add_f32_dpp v69, v69, v69 row_ror:2 row_mask:0xf bank_mask:0xf
    s_nop 0
    v_add_f32_dpp v68, v68, v68 row_ror:1 row_mask:0xf bank_mask:0xf
    v_add_f32_dpp v69, v69, v69 row_ror:1 row_mask:0xf bank_mask:0xf
    s_mov_b32 exec_lo, 0x00010001
    s_mov_b32 exec_hi, 0x00010001
    ds_add_f32 v5, v68 offset:64
    ds_add_f32 v5, v69 offset:68
    s_mov_b64 exec, -1
    s_mov_b32 s7, 0x3a800000
    s_waitcnt lgkmcnt(0)
    s_barrier
    ds_read_b128 v[68:71], v7 offset:64
    ds_read_b128 v[72:75], v7 offset:80
    s_waitcnt lgkmcnt(0)
    v_mul_f32 v68, s7, v68
    v_pk_add_f32 v[70:71], v[70:71], v[74:75]
    v_mul_f32 v76, v68, v68
    v_mul_f32 v72, s7, v72
    v_fma_f32 v69, v69, s7, -v76
    v_mul_f32 v77, v68, v100
    v_max_f32 v69, 0, v69
    v_fma_f32 v76, v68, v101, -v72
    v_add_f32 v69, v69, v107
    v_fma_f32 v70, v70, s7, -v77
    v_rsq_f32 v69, v69
    v_sub_f32 v76, v76, v72
    v_mul_f32 v77, v68, v102
    v_mul_f32 v76, v76, v68
    v_fma_f32 v73, v73, s7, -v77
    v_fma_f32 v71, v71, s7, v76
    v_add_f32 v73, v73, v73
    v_fma_f32 v62, -v68, v180, v66
    v_fma_f32 v70, v70, v69, v103
    v_fma_f32 v71, v71, v69, v73
    v_fma_f32 v63, -v68, v181, v67
    v_fma_f32 v71, v71, v69, v104
    v_fma_f32 v62, v62, v69, v178
    v_fma_f32 v71, -v70, v70, v71
    v_fma_f32 v63, v63, v69, v179
    v_max_f32 v71, 0, v71
    v_sub_f32 v62, v62, v70
    v_add_f32 v71, v71, v107
    v_sub_f32 v63, v63, v70
    v_rsq_f32 v71, v71
    s_nop 0
    v_mul_f32 v62, v62, v71
    v_mul_f32 v63, v63, v71
    v_cvt_pk_bf16_f32 v62, 0, v62
    v_cvt_pk_bf16_f32 v63, 0, v63
    v_bfe_u32 v66, v62, 16, 15
    v_bfe_u32 v67, v63, 16, 15
    v_lshrrev_b32 v68, 31, v62
    v_lshrrev_b32 v69, 31, v63
    v_sub_u32 v66, v66, v105
    v_sub_u32 v67, v67, v105
    v_cmp_ge_u32 s[72:73], v66, v106
    v_cmp_ge_u32 s[74:75], v67, v106
    v_min_u32 v66, 3071, v66
    v_min_u32 v67, 3071, v67
    v_mad_u32_u24 v66, v68, v106, v66
    v_mad_u32_u24 v67, v69, v106, v67
    v_lshlrev_b32 v66, 1, v66
    v_lshlrev_b32 v67, 1, v67
    ds_read_u16 v60, v66 offset:8192
    ds_read_u16 v61, v67 offset:8192
    s_or_b64 vcc, s[72:73], s[74:75]
    s_waitcnt lgkmcnt(0)
    v_lshlrev_b32 v60, 16, v60
    v_lshlrev_b32 v61, 16, v61
    s_cbranch_vccnz L_miss
L_out:
    v_pk_fma_f32 v[60:61], v[60:61], v[182:183], v[64:65]
    v_cvt_pk_bf16_f32 v60, v60, v61
    buffer_store_dword v60, v11, s[64:67], 0 offen
    s_add_u32 s7, s2, s3
    s_cmp_lg_u32 s7, 96
    s_cbranch_scc1 L_fin
    s_mov_b64 exec, 1
    v_mov_b32 v49, s26
    v_mov_b32 v50, 327680
    buffer_store_dword v49, v50, s[56:59], 0 offen
    s_mov_b64 exec, -1
L_fin:
    s_endpgm
L_mlpub:
    v_lshlrev_b32 v14, 3, v1
    ds_read_b64 v[12:13], v14 offset:7424
    s_waitcnt lgkmcnt(0)
    v_mov_b32 v224, v12
    s_nop 1
    v_max_f32_dpp v224, v224, v224 row_ror:8 row_mask:0xf bank_mask:0xf
    v_mov_b32 v226, v224
    s_nop 1
    v_permlane16_swap_b32 v224, v226
    v_max_f32 v224, v224, v226
    v_mov_b32 v226, v224
    s_nop 1
    v_permlane32_swap_b32 v224, v226
    v_max_f32 v224, v224, v226
    v_sub_f32 v225, v12, v224
    v_mul_f32 v225, s14, v225
    v_exp_f32 v225, v225
    s_nop 0
    v_mul_f32 v225, v225, v13
    s_nop 1
    v_add_f32_dpp v225, v225, v225 row_ror:8 row_mask:0xf bank_mask:0xf
    v_mov_b32 v226, v225
    s_nop 1
    v_permlane16_swap_b32 v225, v226
    v_add_f32 v225, v225, v226
    v_mov_b32 v226, v225
    s_nop 1
    v_permlane32_swap_b32 v225, v226
    v_add_f32 v225, v225, v226
    v_min_u32 v224, -2, v224
    v_min_u32 v225, -2, v225
    s_lshl_b32 s9, s5, 11
    s_add_u32 s9, s9, 1703936
    s_lshl_b32 s7, s6, 6
    s_add_u32 s7, s7, s9
    s_mov_b64 exec, 0xff
    buffer_store_dwordx2 v[224:225], v14, s[56:59], s7 offen sc1
    s_mov_b64 exec, -1
    s_mul_i32 s7, s5, 2560
    s_add_u32 s7, s7, 770048
    s_add_u32 s72, s44, s7
    s_addc_u32 s73, s45, 0
    s_mov_b32 s8, 1
    s_atomic_add s8, s[72:73], 0
    s_atomic_add s8, s[72:73], 1280
    s_waitcnt lgkmcnt(0)
    s_branch L_mlback
L_mlget:
    v_mov_b32 v13, 0
LW_130:
    ds_read_b32 v12, v13 offset:60
    s_waitcnt lgkmcnt(0)
    v_readfirstlane_b32 s7, v12
    s_cmp_ge_u32 s7, 4
    s_cbranch_scc1 LWD_131
    s_sleep 2
    s_sub_u32 s10, s10, 1
    s_cbranch_scc0 LW_130
    s_mov_b32 s10, 0
LWD_131:
    s_nop 4
    v_mov_b32 v13, 0
LW_132:
    ds_read_b32 v12, v13 offset:8
    s_waitcnt lgkmcnt(0)
    v_readfirstlane_b32 s7, v12
    s_cmp_ge_u32 s7, 8
    s_cbranch_scc1 LWD_133
    s_sleep 2
    s_sub_u32 s10, s10, 1
    s_cbranch_scc0 LW_132
    s_mov_b32 s10, 0
LWD_133:
    s_nop 4
    s_mul_i32 s7, s5, 2
    s_and_b32 s8, s6, 1
    s_add_u32 s7, s7, s8
    s_mul_i32 s7, s7, 1280
    s_add_u32 s7, s7, 770048
MG_134:
    s_load_dword s8, s[44:45], s7 glc
    s_waitcnt lgkmcnt(0)
    s_cmp_ge_i32 s8, 31
    s_cbranch_scc1 MGD_135
    s_sleep 6
    s_sub_u32 s10, s10, 1
    s_cbranch_scc0 MG_134
    s_mov_b32 s10, 0
MGD_135:
    v_lshlrev_b32 v14, 3, v1
    ds_read_b64 v[12:13], v14 offset:7424
    s_lshl_b32 s9, s5, 11
    s_add_u32 s9, s9, 1703936
    s_waitcnt lgkmcnt(0)
PA_136:
    buffer_load_dwordx2 v[228:229], v14, s[56:59], s9 offen offset:0 sc1
    buffer_load_dwordx2 v[230:231], v14, s[56:59], s9 offen offset:512 sc1
    buffer_load_dwordx2 v[232:233], v14, s[56:59], s9 offen offset:1024 sc1
    buffer_load_dwordx2 v[234:235], v14, s[56:59], s9 offen offset:1536 sc1
    s_waitcnt vmcnt(0)
    v_max3_u32 v226, v228, v229, v230
    v_max3_u32 v226, v226, v231, v232
    v_max3_u32 v226, v226, v233, v234
    v_max_u32 v226, v226, v235
    v_cmp_eq_u32 vcc, -1, v226
    s_cbranch_vccz PAD_137
    s_sleep 12
    s_sub_u32 s10, s10, 1
    s_cbranch_scc0 PA_136
    s_mov_b32 s10, 0
PAD_137:
    s_nop 4
    v_max3_f32 v224, v228, v230, v232
    v_max_f32 v224, v224, v234
    s_nop 1
    v_max_f32_dpp v224, v224, v224 row_ror:8 row_mask:0xf bank_mask:0xf
    v_mov_b32 v226, v224
    s_nop 1
    v_permlane16_swap_b32 v224, v226
    v_max_f32 v224, v224, v226
    v_mov_b32 v226, v224
    s_nop 1
    v_permlane32_swap_b32 v224, v226
    v_max_f32 v224, v224, v226
    v_sub_f32 v228, v228, v224
    v_mul_f32 v228, s14, v228
    v_exp_f32 v228, v228
    v_sub_f32 v230, v230, v224
    v_mul_f32 v230, s14, v230
    v_exp_f32 v230, v230
    v_sub_f32 v232, v232, v224
    v_mul_f32 v232, s14, v232
    v_exp_f32 v232, v232
    v_sub_f32 v234, v234, v224
    v_mul_f32 v234, s14, v234
    v_exp_f32 v234, v234
    v_mul_f32 v225, v228, v229
    v_fmac_f32 v225, v230, v231
    v_fmac_f32 v225, v232, v233
    v_fmac_f32 v225, v234, v235
    s_nop 1
    v_add_f32_dpp v225, v225, v225 row_ror:8 row_mask:0xf bank_mask:0xf
    v_mov_b32 v226, v225
    s_nop 1
    v_permlane16_swap_b32 v225, v226
    v_add_f32 v225, v225, v226
    v_mov_b32 v226, v225
    s_nop 1
    v_permlane32_swap_b32 v225, v226
    v_add_f32 v225, v225, v226
    v_rcp_f32 v225, v225
    v_sub_f32 v12, v12, v224
    v_mul_f32 v12, s14, v12
    v_exp_f32 v12, v12
    s_nop 0
    v_mul_f32 v12, v12, v225
    v_lshlrev_b32 v14, 2, v1
    ds_write_b32 v14, v12 offset:7936
    v_mov_b32 v224, 1
    v_mov_b32 v225, 0
    ds_write_b32 v225, v224 offset:12
    s_branch L_mlgot
L_tab:
    s_setprio 0
    s_cmp_lt_u32 s3, 4
    s_cbranch_scc1 L_tab0
    s_setprio 1
L_tab0:
    v_lshlrev_b32 v28, 2, v0
    v_lshlrev_b32 v29, 1, v0
    s_mov_b32 s64, s28
    s_mov_b32 s65, s29
    s_mov_b32 s66, 7168
    s_mov_b32 s67, 0x20000
    s_movk_i32 s7, 0x1000
    buffer_load_dword v90, v28, s[64:67], 0 offen
    buffer_load_dword v91, v28, s[64:67], 0 offen offset:2048
    buffer_load_dword v92, v28, s[64:67], s7 offen
    buffer_load_ushort v93, v29, s[64:67], s7 offen offset:2048
    s_mov_b32 s64, s30
    s_mov_b32 s65, s31
    s_mov_b32 s66, 7168
    s_mov_b32 s67, 0x20000
    s_movk_i32 s7, 0x1000
    buffer_load_dword v94, v28, s[64:67], 0 offen
    buffer_load_dword v95, v28, s[64:67], 0 offen offset:2048
    buffer_load_dword v96, v28, s[64:67], s7 offen
    buffer_load_ushort v97, v29, s[64:67], s7 offen offset:2048
    s_mov_b32 s64, s32
    s_mov_b32 s65, s33
    s_mov_b32 s66, 7168
    s_mov_b32 s67, 0x20000
    s_movk_i32 s7, 0x1000
    buffer_load_dword v98, v28, s[64:67], 0 offen
    buffer_load_dword v99, v28, s[64:67], 0 offen offset:2048
    buffer_load_dword v100, v28, s[64:67], s7 offen
    buffer_load_ushort v101, v29, s[64:67], s7 offen offset:2048
    s_load_dword s46, s[34:35], 0
    s_load_dword s26, s[44:45], 327680
    s_waitcnt lgkmcnt(0)
    s_mul_i32 s26, s26, 0x9e3779b1
    s_add_u32 s26, s26, 0x7f4a7c15
    s_and_b32 s8, s2, 127
    s_mul_i32 s8, s8, 24
    s_add_u32 s8, s8, 13824
    s_lshr_b32 s9, s2, 7
    s_lshl_b32 s9, s9, 15
    s_add_u32 s8, s8, s9
    s_lshl_b32 s8, s8, 16
    s_mov_b32 s9, 0
    s_waitcnt vmcnt(0)
    s_mov_b32 s7, 0xbdd2d3e8
    v_mov_b32 v32, 0xc0135761
    v_lshlrev_b32 v28, 16, v90
    v_lshlrev_b32 v29, 16, v94
    v_lshlrev_b32 v30, 16, v98
    v_mul_f32 v31, v29, v29
    v_mul_f32 v33, v28, v28
    v_mul_f32 v31, s7, v31
    v_mul_f32 v33, s7, v33
    v_add_f32 v48, v32, v31
    v_fmaak_f32 v48, v48, v29, 0xc27c0000
    v_fmamk_f32 v49, v31, 0x40400000, v32
    v_mul_f32 v49, v49, v28
    v_mul_f32 v51, v33, v28
    v_mul_f32 v33, v33, v29
    v_mul_f32 v50, 0x40400000, v33
    v_mul_f32 v52, v29, v30
    v_mul_f32 v53, v28, v30
    v_and_b32 v28, 0xffff0000, v90
    v_and_b32 v29, 0xffff0000, v94
    v_and_b32 v30, 0xffff0000, v98
    v_mul_f32 v31, v29, v29
    v_mul_f32 v33, v28, v28
    v_mul_f32 v31, s7, v31
    v_mul_f32 v33, s7, v33
    v_add_f32 v54, v32, v31
    v_fmaak_f32 v54, v54, v29, 0xc27c0000
    v_fmamk_f32 v55, v31, 0x40400000, v32
    v_mul_f32 v55, v55, v28
    v_mul_f32 v57, v33, v28
    v_mul_f32 v33, v33, v29
    v_mul_f32 v56, 0x40400000, v33
    v_mul_f32 v58, v29, v30
    v_mul_f32 v59, v28, v30
    v_lshlrev_b32 v28, 16, v91
    v_lshlrev_b32 v29, 16, v95
    v_lshlrev_b32 v30, 16, v99
    v_mul_f32 v31, v29, v29
    v_mul_f32 v33, v28, v28
    v_mul_f32 v31, s7, v31
    v_mul_f32 v33, s7, v33
    v_add_f32 v60, v32, v31
    v_fmaak_f32 v60, v60, v29, 0xc27c0000
    v_fmamk_f32 v61, v31, 0x40400000, v32
    v_mul_f32 v61, v61, v28
    v_mul_f32 v63, v33, v28
    v_mul_f32 v33, v33, v29
    v_mul_f32 v62, 0x40400000, v33
    v_mul_f32 v64, v29, v30
    v_mul_f32 v65, v28, v30
    v_and_b32 v28, 0xffff0000, v91
    v_and_b32 v29, 0xffff0000, v95
    v_and_b32 v30, 0xffff0000, v99
    v_mul_f32 v31, v29, v29
    v_mul_f32 v33, v28, v28
    v_mul_f32 v31, s7, v31
    v_mul_f32 v33, s7, v33
    v_add_f32 v66, v32, v31
    v_fmaak_f32 v66, v66, v29, 0xc27c0000
    v_fmamk_f32 v67, v31, 0x40400000, v32
    v_mul_f32 v67, v67, v28
    v_mul_f32 v69, v33, v28
    v_mul_f32 v33, v33, v29
    v_mul_f32 v68, 0x40400000, v33
    v_mul_f32 v70, v29, v30
    v_mul_f32 v71, v28, v30
    v_lshlrev_b32 v28, 16, v92
    v_lshlrev_b32 v29, 16, v96
    v_lshlrev_b32 v30, 16, v100
    v_mul_f32 v31, v29, v29
    v_mul_f32 v33, v28, v28
    v_mul_f32 v31, s7, v31
    v_mul_f32 v33, s7, v33
    v_add_f32 v72, v32, v31
    v_fmaak_f32 v72, v72, v29, 0xc27c0000
    v_fmamk_f32 v73, v31, 0x40400000, v32
    v_mul_f32 v73, v73, v28
    v_mul_f32 v75, v33, v28
    v_mul_f32 v33, v33, v29
    v_mul_f32 v74, 0x40400000, v33
    v_mul_f32 v76, v29, v30
    v_mul_f32 v77, v28, v30
    v_and_b32 v28, 0xffff0000, v92
    v_and_b32 v29, 0xffff0000, v96
    v_and_b32 v30, 0xffff0000, v100
    v_mul_f32 v31, v29, v29
    v_mul_f32 v33, v28, v28
    v_mul_f32 v31, s7, v31
    v_mul_f32 v33, s7, v33
    v_add_f32 v78, v32, v31
    v_fmaak_f32 v78, v78, v29, 0xc27c0000
    v_fmamk_f32 v79, v31, 0x40400000, v32
    v_mul_f32 v79, v79, v28
    v_mul_f32 v81, v33, v28
    v_mul_f32 v33, v33, v29
    v_mul_f32 v80, 0x40400000, v33
    v_mul_f32 v82, v29, v30
    v_mul_f32 v83, v28, v30
    v_lshlrev_b32 v28, 16, v93
    v_lshlrev_b32 v29, 16, v97
    v_lshlrev_b32 v30, 16, v101
    v_mul_f32 v31, v29, v29
    v_mul_f32 v33, v28, v28
    v_mul_f32 v31, s7, v31
    v_mul_f32 v33, s7, v33
    v_add_f32 v84, v32, v31
    v_fmaak_f32 v84, v84, v29, 0xc27c0000
    v_fmamk_f32 v85, v31, 0x40400000, v32
    v_mul_f32 v85, v85, v28
    v_mul_f32 v87, v33, v28
    v_mul_f32 v33, v33, v29
    v_mul_f32 v86, 0x40400000, v33
    v_mul_f32 v88, v29, v30
    v_mul_f32 v89, v28, v30
    v_mov_b32 v34, 0x20000000
    v_mov_b32 v35, 0x20000000
    v_lshlrev_b32 v36, 3, v2
L_tabl:
    s_add_u32 s72, s8, 0
    s_add_u32 s73, s8, 65536
    s_add_u32 s74, s8, 131072
    s_add_u32 s75, s8, 196608
    s_add_u32 s76, s8, 262144
    s_add_u32 s77, s8, 327680
    s_add_u32 s78, s8, 393216
    s_add_u32 s79, s8, 458752
    v_pk_fma_f32 v[90:91], v[86:87], s[72:73], v[86:87] op_sel:[1,0,0] op_sel_hi:[1,1,0]
    v_pk_fma_f32 v[92:93], v[86:87], s[74:75], v[86:87] op_sel:[1,0,0] op_sel_hi:[1,1,0]
    v_pk_fma_f32 v[94:95], v[86:87], s[76:77], v[86:87] op_sel:[1,0,0] op_sel_hi:[1,1,0]
    v_pk_fma_f32 v[96:97], v[86:87], s[78:79], v[86:87] op_sel:[1,0,0] op_sel_hi:[1,1,0]
    v_pk_fma_f32 v[90:91], v[90:91], s[72:73], v[84:85] op_sel:[0,0,1] op_sel_hi:[1,1,1]
    v_pk_fma_f32 v[92:93], v[92:93], s[74:75], v[84:85] op_sel:[0,0,1] op_sel_hi:[1,1,1]
    v_pk_fma_f32 v[94:95], v[94:95], s[76:77], v[84:85] op_sel:[0,0,1] op_sel_hi:[1,1,1]
    v_pk_fma_f32 v[96:97], v[96:97], s[78:79], v[84:85] op_sel:[0,0,1] op_sel_hi:[1,1,1]
    v_pk_fma_f32 v[90:91], v[90:91], s[72:73], v[84:85] op_sel:[0,0,0] op_sel_hi:[1,1,0]
    v_pk_fma_f32 v[92:93], v[92:93], s[74:75], v[84:85] op_sel:[0,0,0] op_sel_hi:[1,1,0]
    v_pk_fma_f32 v[94:95], v[94:95], s[76:77], v[84:85] op_sel:[0,0,0] op_sel_hi:[1,1,0]
    v_pk_fma_f32 v[96:97], v[96:97], s[78:79], v[84:85] op_sel:[0,0,0] op_sel_hi:[1,1,0]
    v_exp_f32_e64 v90, v90 clamp
    v_exp_f32_e64 v91, v91 clamp
    v_exp_f32_e64 v92, v92 clamp
    v_exp_f32_e64 v93, v93 clamp
    v_exp_f32_e64 v94, v94 clamp
    v_exp_f32_e64 v95, v95 clamp
    v_exp_f32_e64 v96, v96 clamp
    v_exp_f32_e64 v97, v97 clamp
    v_pk_fma_f32 v[106:107], v[88:89], s[72:73], v[88:89] op_sel:[1,0,0] op_sel_hi:[1,1,0]
    v_pk_fma_f32 v[108:109], v[88:89], s[74:75], v[88:89] op_sel:[1,0,0] op_sel_hi:[1,1,0]
    v_pk_fma_f32 v[110:111], v[88:89], s[76:77], v[88:89] op_sel:[1,0,0] op_sel_hi:[1,1,0]
    v_pk_fma_f32 v[112:113], v[88:89], s[78:79], v[88:89] op_sel:[1,0,0] op_sel_hi:[1,1,0]
    v_pk_add_f32 v[90:91], v[90:91], v[34:35]
    v_pk_add_f32 v[92:93], v[92:93], v[34:35]
    v_pk_add_f32 v[94:95], v[94:95], v[34:35]
    v_pk_add_f32 v[96:97], v[96:97], v[34:35]
    v_rcp_f32 v90, v90
    v_rcp_f32 v91, v91
    v_rcp_f32 v92, v92
    v_rcp_f32 v93, v93
    v_rcp_f32 v94, v94
    v_rcp_f32 v95, v95
    v_rcp_f32 v96, v96
    v_rcp_f32 v97, v97
    v_pk_mul_f32 v[38:39], v[106:107], v[90:91]
    v_pk_mul_f32 v[40:41], v[108:109], v[92:93]
    v_pk_mul_f32 v[42:43], v[110:111], v[94:95]
    v_pk_mul_f32 v[44:45], v[112:113], v[96:97]
    v_pk_fma_f32 v[90:91], v[50:51], s[72:73], v[50:51] op_sel:[1,0,0] op_sel_hi:[1,1,0]
    v_pk_fma_f32 v[92:93], v[50:51], s[74:75], v[50:51] op_sel:[1,0,0] op_sel_hi:[1,1,0]
    v_pk_fma_f32 v[94:95], v[50:51], s[76:77], v[50:51] op_sel:[1,0,0] op_sel_hi:[1,1,0]
    v_pk_fma_f32 v[96:97], v[50:51], s[78:79], v[50:51] op_sel:[1,0,0] op_sel_hi:[1,1,0]
    v_pk_fma_f32 v[90:91], v[90:91], s[72:73], v[48:49] op_sel:[0,0,1] op_sel_hi:[1,1,1]
    v_pk_fma_f32 v[92:93], v[92:93], s[74:75], v[48:49] op_sel:[0,0,1] op_sel_hi:[1,1,1]
    v_pk_fma_f32 v[94:95], v[94:95], s[76:77], v[48:49] op_sel:[0,0,1] op_sel_hi:[1,1,1]
    v_pk_fma_f32 v[96:97], v[96:97], s[78:79], v[48:49] op_sel:[0,0,1] op_sel_hi:[1,1,1]
    v_pk_fma_f32 v[90:91], v[90:91], s[72:73], v[48:49] op_sel:[0,0,0] op_sel_hi:[1,1,0]
    v_pk_fma_f32 v[92:93], v[92:93], s[74:75], v[48:49] op_sel:[0,0,0] op_sel_hi:[1,1,0]
    v_pk_fma_f32 v[94:95], v[94:95], s[76:77], v[48:49] op_sel:[0,0,0] op_sel_hi:[1,1,0]
    v_pk_fma_f32 v[96:97], v[96:97], s[78:79], v[48:49] op_sel:[0,0,0] op_sel_hi:[1,1,0]
    v_exp_f32_e64 v90, v90 clamp
    v_exp_f32_e64 v91, v91 clamp
    v_exp_f32_e64 v92, v92 clamp
    v_exp_f32_e64 v93, v93 clamp
    v_exp_f32_e64 v94, v94 clamp
    v_exp_f32_e64 v95, v95 clamp
    v_exp_f32_e64 v96, v96 clamp
    v_exp_f32_e64 v97, v97 clamp
    v_pk_fma_f32 v[106:107], v[52:53], s[72:73], v[52:53] op_sel:[1,0,0] op_sel_hi:[1,1,0]
    v_pk_fma_f32 v[108:109], v[52:53], s[74:75], v[52:53] op_sel:[1,0,0] op_sel_hi:[1,1,0]
    v_pk_fma_f32 v[110:111], v[52:53], s[76:77], v[52:53] op_sel:[1,0,0] op_sel_hi:[1,1,0]
    v_pk_fma_f32 v[112:113], v[52:53], s[78:79], v[52:53] op_sel:[1,0,0] op_sel_hi:[1,1,0]
    v_pk_add_f32 v[90:91], v[90:91], v[34:35]
    v_pk_add_f32 v[92:93], v[92:93], v[34:35]
    v_pk_add_f32 v[94:95], v[94:95], v[34:35]
    v_pk_add_f32 v[96:97], v[96:97], v[34:35]
    v_pk_fma_f32 v[98:99], v[56:57], s[72:73], v[56:57] op_sel:[1,0,0] op_sel_hi:[1,1,0]
    v_pk_fma_f32 v[100:101], v[56:57], s[74:75], v[56:57] op_sel:[1,0,0] op_sel_hi:[1,1,0]
    v_pk_fma_f32 v[102:103], v[56:57], s[76:77], v[56:57] op_sel:[1,0,0] op_sel_hi:[1,1,0]
    v_pk_fma_f32 v[104:105], v[56:57], s[78:79], v[56:57] op_sel:[1,0,0] op_sel_hi:[1,1,0]
    v_pk_fma_f32 v[98:99], v[98:99], s[72:73], v[54:55] op_sel:[0,0,1] op_sel_hi:[1,1,1]
    v_pk_fma_f32 v[100:101], v[100:101], s[74:75], v[54:55] op_sel:[0,0,1] op_sel_hi:[1,1,1]
    v_pk_fma_f32 v[102:103], v[102:103], s[76:77], v[54:55] op_sel:[0,0,1] op_sel_hi:[1,1,1]
    v_pk_fma_f32 v[104:105], v[104:105], s[78:79], v[54:55] op_sel:[0,0,1] op_sel_hi:[1,1,1]
    v_pk_fma_f32 v[98:99], v[98:99], s[72:73], v[54:55] op_sel:[0,0,0] op_sel_hi:[1,1,0]
    v_pk_fma_f32 v[100:101], v[100:101], s[74:75], v[54:55] op_sel:[0,0,0] op_sel_hi:[1,1,0]
    v_pk_fma_f32 v[102:103], v[102:103], s[76:77], v[54:55] op_sel:[0,0,0] op_sel_hi:[1,1,0]
    v_pk_fma_f32 v[104:105], v[104:105], s[78:79], v[54:55] op_sel:[0,0,0] op_sel_hi:[1,1,0]
    v_exp_f32_e64 v98, v98 clamp
    v_exp_f32_e64 v99, v99 clamp
    v_exp_f32_e64 v100, v100 clamp
    v_exp_f32_e64 v101, v101 clamp
    v_exp_f32_e64 v102, v102 clamp
    v_exp_f32_e64 v103, v103 clamp
    v_exp_f32_e64 v104, v104 clamp
    v_exp_f32_e64 v105, v105 clamp
    v_pk_fma_f32 v[114:115], v[58:59], s[72:73], v[58:59] op_sel:[1,0,0] op_sel_hi:[1,1,0]
    v_pk_fma_f32 v[116:117], v[58:59], s[74:75], v[58:59] op_sel:[1,0,0] op_sel_hi:[1,1,0]
    v_pk_fma_f32 v[118:119], v[58:59], s[76:77], v[58:59] op_sel:[1,0,0] op_sel_hi:[1,1,0]
    v_pk_fma_f32 v[120:121], v[58:59], s[78:79], v[58:59] op_sel:[1,0,0] op_sel_hi:[1,1,0]
    v_pk_add_f32 v[98:99], v[98:99], v[34:35]
    v_pk_add_f32 v[100:101], v[100:101], v[34:35]
    v_pk_add_f32 v[102:103], v[102:103], v[34:35]
    v_pk_add_f32 v[104:105], v[104:105], v[34:35]
    v_pk_mul_f32 v[106:107], v[106:107], v[98:99]
    v_pk_mul_f32 v[108:109], v[108:109], v[100:101]
    v_pk_mul_f32 v[110:111], v[110:111], v[102:103]
    v_pk_mul_f32 v[112:113], v[112:113], v[104:105]
    v_pk_fma_f32 v[106:107], v[114:115], v[90:91], v[106:107]
    v_pk_fma_f32 v[108:109], v[116:117], v[92:93], v[108:109]
    v_pk_fma_f32 v[110:111], v[118:119], v[94:95], v[110:111]
    v_pk_fma_f32 v[112:113], v[120:121], v[96:97], v[112:113]
    v_pk_mul_f32 v[90:91], v[90:91], v[98:99]
    v_pk_mul_f32 v[92:93], v[92:93], v[100:101]
    v_pk_mul_f32 v[94:95], v[94:95], v[102:103]
    v_pk_mul_f32 v[96:97], v[96:97], v[104:105]
    v_rcp_f32 v90, v90
    v_rcp_f32 v91, v91
    v_rcp_f32 v92, v92
    v_rcp_f32 v93, v93
    v_rcp_f32 v94, v94
    v_rcp_f32 v95, v95
    v_rcp_f32 v96, v96
    v_rcp_f32 v97, v97
    v_pk_fma_f32 v[38:39], v[106:107], v[90:91], v[38:39]
    v_pk_fma_f32 v[40:41], v[108:109], v[92:93], v[40:41]
    v_pk_fma_f32 v[42:43], v[110:111], v[94:95], v[42:43]
    v_pk_fma_f32 v[44:45], v[112:113], v[96:97], v[44:45]
    v_pk_fma_f32 v[90:91], v[62:63], s[72:73], v[62:63] op_sel:[1,0,0] op_sel_hi:[1,1,0]
    v_pk_fma_f32 v[92:93], v[62:63], s[74:75], v[62:63] op_sel:[1,0,0] op_sel_hi:[1,1,0]
    v_pk_fma_f32 v[94:95], v[62:63], s[76:77], v[62:63] op_sel:[1,0,0] op_sel_hi:[1,1,0]
    v_pk_fma_f32 v[96:97], v[62:63], s[78:79], v[62:63] op_sel:[1,0,0] op_sel_hi:[1,1,0]
    v_pk_fma_f32 v[90:91], v[90:91], s[72:73], v[60:61] op_sel:[0,0,1] op_sel_hi:[1,1,1]
    v_pk_fma_f32 v[92:93], v[92:93], s[74:75], v[60:61] op_sel:[0,0,1] op_sel_hi:[1,1,1]
    v_pk_fma_f32 v[94:95], v[94:95], s[76:77], v[60:61] op_sel:[0,0,1] op_sel_hi:[1,1,1]
    v_pk_fma_f32 v[96:97], v[96:97], s[78:79], v[60:61] op_sel:[0,0,1] op_sel_hi:[1,1,1]
    v_pk_fma_f32 v[90:91], v[90:91], s[72:73], v[60:61] op_sel:[0,0,0] op_sel_hi:[1,1,0]
    v_pk_fma_f32 v[92:93], v[92:93], s[74:75], v[60:61] op_sel:[0,0,0] op_sel_hi:[1,1,0]
    v_pk_fma_f32 v[94:95], v[94:95], s[76:77], v[60:61] op_sel:[0,0,0] op_sel_hi:[1,1,0]
    v_pk_fma_f32 v[96:97], v[96:97], s[78:79], v[60:61] op_sel:[0,0,0] op_sel_hi:[1,1,0]
    v_exp_f32_e64 v90, v90 clamp
    v_exp_f32_e64 v91, v91 clamp
    v_exp_f32_e64 v92, v92 clamp
    v_exp_f32_e64 v93, v93 clamp
    v_exp_f32_e64 v94, v94 clamp
    v_exp_f32_e64 v95, v95 clamp
    v_exp_f32_e64 v96, v96 clamp
    v_exp_f32_e64 v97, v97 clamp
    v_pk_fma_f32 v[106:107], v[64:65], s[72:73], v[64:65] op_sel:[1,0,0] op_sel_hi:[1,1,0]
    v_pk_fma_f32 v[108:109], v[64:65], s[74:75], v[64:65] op_sel:[1,0,0] op_sel_hi:[1,1,0]
    v_pk_fma_f32 v[110:111], v[64:65], s[76:77], v[64:65] op_sel:[1,0,0] op_sel_hi:[1,1,0]
    v_pk_fma_f32 v[112:113], v[64:65], s[78:79], v[64:65] op_sel:[1,0,0] op_sel_hi:[1,1,0]
    v_pk_add_f32 v[90:91], v[90:91], v[34:35]
    v_pk_add_f32 v[92:93], v[92:93], v[34:35]
    v_pk_add_f32 v[94:95], v[94:95], v[34:35]
    v_pk_add_f32 v[96:97], v[96:97], v[34:35]
    v_pk_fma_f32 v[98:99], v[68:69], s[72:73], v[68:69] op_sel:[1,0,0] op_sel_hi:[1,1,0]
    v_pk_fma_f32 v[100:101], v[68:69], s[74:75], v[68:69] op_sel:[1,0,0] op_sel_hi:[1,1,0]
    v_pk_fma_f32 v[102:103], v[68:69], s[76:77], v[68:69] op_sel:[1,0,0] op_sel_hi:[1,1,0]
    v_pk_fma_f32 v[104:105], v[68:69], s[78:79], v[68:69] op_sel:[1,0,0] op_sel_hi:[1,1,0]
    v_pk_fma_f32 v[98:99], v[98:99], s[72:73], v[66:67] op_sel:[0,0,1] op_sel_hi:[1,1,1]
    v_pk_fma_f32 v[100:101], v[100:101], s[74:75], v[66:67] op_sel:[0,0,1] op_sel_hi:[1,1,1]
    v_pk_fma_f32 v[102:103], v[102:103], s[76:77], v[66:67] op_sel:[0,0,1] op_sel_hi:[1,1,1]
    v_pk_fma_f32 v[104:105], v[104:105], s[78:79], v[66:67] op_sel:[0,0,1] op_sel_hi:[1,1,1]
    v_pk_fma_f32 v[98:99], v[98:99], s[72:73], v[66:67] op_sel:[0,0,0] op_sel_hi:[1,1,0]
    v_pk_fma_f32 v[100:101], v[100:101], s[74:75], v[66:67] op_sel:[0,0,0] op_sel_hi:[1,1,0]
    v_pk_fma_f32 v[102:103], v[102:103], s[76:77], v[66:67] op_sel:[0,0,0] op_sel_hi:[1,1,0]
    v_pk_fma_f32 v[104:105], v[104:105], s[78:79], v[66:67] op_sel:[0,0,0] op_sel_hi:[1,1,0]
    v_exp_f32_e64 v98, v98 clamp
    v_exp_f32_e64 v99, v99 clamp
    v_exp_f32_e64 v100, v100 clamp
    v_exp_f32_e64 v101, v101 clamp
    v_exp_f32_e64 v102, v102 clamp
    v_exp_f32_e64 v103, v103 clamp
    v_exp_f32_e64 v104, v104 clamp
    v_exp_f32_e64 v105, v105 clamp
    v_pk_fma_f32 v[114:115], v[70:71], s[72:73], v[70:71] op_sel:[1,0,0] op_sel_hi:[1,1,0]
    v_pk_fma_f32 v[116:117], v[70:71], s[74:75], v[70:71] op_sel:[1,0,0] op_sel_hi:[1,1,0]
    v_pk_fma_f32 v[118:119], v[70:71], s[76:77], v[70:71] op_sel:[1,0,0] op_sel_hi:[1,1,0]
    v_pk_fma_f32 v[120:121], v[70:71], s[78:79], v[70:71] op_sel:[1,0,0] op_sel_hi:[1,1,0]
    v_pk_add_f32 v[98:99], v[98:99], v[34:35]
    v_pk_add_f32 v[100:101], v[100:101], v[34:35]
    v_pk_add_f32 v[102:103], v[102:103], v[34:35]
    v_pk_add_f32 v[104:105], v[104:105], v[34:35]
    v_pk_mul_f32 v[106:107], v[106:107], v[98:99]
    v_pk_mul_f32 v[108:109], v[108:109], v[100:101]
    v_pk_mul_f32 v[110:111], v[110:111], v[102:103]
    v_pk_mul_f32 v[112:113], v[112:113], v[104:105]
    v_pk_fma_f32 v[106:107], v[114:115], v[90:91], v[106:107]
    v_pk_fma_f32 v[108:109], v[116:117], v[92:93], v[108:109]
    v_pk_fma_f32 v[110:111], v[118:119], v[94:95], v[110:111]
    v_pk_fma_f32 v[112:113], v[120:121], v[96:97], v[112:113]
    v_pk_mul_f32 v[90:91], v[90:91], v[98:99]
    v_pk_mul_f32 v[92:93], v[92:93], v[100:101]
    v_pk_mul_f32 v[94:95], v[94:95], v[102:103]
    v_pk_mul_f32 v[96:97], v[96:97], v[104:105]
    v_rcp_f32 v90, v90
    v_rcp_f32 v91, v91
    v_rcp_f32 v92, v92
    v_rcp_f32 v93, v93
    v_rcp_f32 v94, v94
    v_rcp_f32 v95, v95
    v_rcp_f32 v96, v96
    v_rcp_f32 v97, v97
    v_pk_fma_f32 v[38:39], v[106:107], v[90:91], v[38:39]
    v_pk_fma_f32 v[40:41], v[108:109], v[92:93], v[40:41]
    v_pk_fma_f32 v[42:43], v[110:111], v[94:95], v[42:43]
    v_pk_fma_f32 v[44:45], v[112:113], v[96:97], v[44:45]
    v_pk_fma_f32 v[90:91], v[74:75], s[72:73], v[74:75] op_sel:[1,0,0] op_sel_hi:[1,1,0]
    v_pk_fma_f32 v[92:93], v[74:75], s[74:75], v[74:75] op_sel:[1,0,0] op_sel_hi:[1,1,0]
    v_pk_fma_f32 v[94:95], v[74:75], s[76:77], v[74:75] op_sel:[1,0,0] op_sel_hi:[1,1,0]
    v_pk_fma_f32 v[96:97], v[74:75], s[78:79], v[74:75] op_sel:[1,0,0] op_sel_hi:[1,1,0]
    v_pk_fma_f32 v[90:91], v[90:91], s[72:73], v[72:73] op_sel:[0,0,1] op_sel_hi:[1,1,1]
    v_pk_fma_f32 v[92:93], v[92:93], s[74:75], v[72:73] op_sel:[0,0,1] op_sel_hi:[1,1,1]
    v_pk_fma_f32 v[94:95], v[94:95], s[76:77], v[72:73] op_sel:[0,0,1] op_sel_hi:[1,1,1]
    v_pk_fma_f32 v[96:97], v[96:97], s[78:79], v[72:73] op_sel:[0,0,1] op_sel_hi:[1,1,1]
    v_pk_fma_f32 v[90:91], v[90:91], s[72:73], v[72:73] op_sel:[0,0,0] op_sel_hi:[1,1,0]
    v_pk_fma_f32 v[92:93], v[92:93], s[74:75], v[72:73] op_sel:[0,0,0] op_sel_hi:[1,1,0]
    v_pk_fma_f32 v[94:95], v[94:95], s[76:77], v[72:73] op_sel:[0,0,0] op_sel_hi:[1,1,0]
    v_pk_fma_f32 v[96:97], v[96:97], s[78:79], v[72:73] op_sel:[0,0,0] op_sel_hi:[1,1,0]
    v_exp_f32_e64 v90, v90 clamp
    v_exp_f32_e64 v91, v91 clamp
    v_exp_f32_e64 v92, v92 clamp
    v_exp_f32_e64 v93, v93 clamp
    v_exp_f32_e64 v94, v94 clamp
    v_exp_f32_e64 v95, v95 clamp
    v_exp_f32_e64 v96, v96 clamp
    v_exp_f32_e64 v97, v97 clamp
    v_pk_fma_f32 v[106:107], v[76:77], s[72:73], v[76:77] op_sel:[1,0,0] op_sel_hi:[1,1,0]
    v_pk_fma_f32 v[108:109], v[76:77], s[74:75], v[76:77] op_sel:[1,0,0] op_sel_hi:[1,1,0]
    v_pk_fma_f32 v[110:111], v[76:77], s[76:77], v[76:77] op_sel:[1,0,0] op_sel_hi:[1,1,0]
    v_pk_fma_f32 v[112:113], v[76:77], s[78:79], v[76:77] op_sel:[1,0,0] op_sel_hi:[1,1,0]
    v_pk_add_f32 v[90:91], v[90:91], v[34:35]
    v_pk_add_f32 v[92:93], v[92:93], v[34:35]
    v_pk_add_f32 v[94:95], v[94:95], v[34:35]
    v_pk_add_f32 v[96:97], v[96:97], v[34:35]
    v_pk_fma_f32 v[98:99], v[80:81], s[72:73], v[80:81] op_sel:[1,0,0] op_sel_hi:[1,1,0]
    v_pk_fma_f32 v[100:101], v[80:81], s[74:75], v[80:81] op_sel:[1,0,0] op_sel_hi:[1,1,0]
    v_pk_fma_f32 v[102:103], v[80:81], s[76:77], v[80:81] op_sel:[1,0,0] op_sel_hi:[1,1,0]
    v_pk_fma_f32 v[104:105], v[80:81], s[78:79], v[80:81] op_sel:[1,0,0] op_sel_hi:[1,1,0]
    v_pk_fma_f32 v[98:99], v[98:99], s[72:73], v[78:79] op_sel:[0,0,1] op_sel_hi:[1,1,1]
    v_pk_fma_f32 v[100:101], v[100:101], s[74:75], v[78:79] op_sel:[0,0,1] op_sel_hi:[1,1,1]
    v_pk_fma_f32 v[102:103], v[102:103], s[76:77], v[78:79] op_sel:[0,0,1] op_sel_hi:[1,1,1]
    v_pk_fma_f32 v[104:105], v[104:105], s[78:79], v[78:79] op_sel:[0,0,1] op_sel_hi:[1,1,1]
    v_pk_fma_f32 v[98:99], v[98:99], s[72:73], v[78:79] op_sel:[0,0,0] op_sel_hi:[1,1,0]
    v_pk_fma_f32 v[100:101], v[100:101], s[74:75], v[78:79] op_sel:[0,0,0] op_sel_hi:[1,1,0]
    v_pk_fma_f32 v[102:103], v[102:103], s[76:77], v[78:79] op_sel:[0,0,0] op_sel_hi:[1,1,0]
    v_pk_fma_f32 v[104:105], v[104:105], s[78:79], v[78:79] op_sel:[0,0,0] op_sel_hi:[1,1,0]
    v_exp_f32_e64 v98, v98 clamp
    v_exp_f32_e64 v99, v99 clamp
    v_exp_f32_e64 v100, v100 clamp
    v_exp_f32_e64 v101, v101 clamp
    v_exp_f32_e64 v102, v102 clamp
    v_exp_f32_e64 v103, v103 clamp
    v_exp_f32_e64 v104, v104 clamp
    v_exp_f32_e64 v105, v105 clamp
    v_pk_fma_f32 v[114:115], v[82:83], s[72:73], v[82:83] op_sel:[1,0,0] op_sel_hi:[1,1,0]
    v_pk_fma_f32 v[116:117], v[82:83], s[74:75], v[82:83] op_sel:[1,0,0] op_sel_hi:[1,1,0]
    v_pk_fma_f32 v[118:119], v[82:83], s[76:77], v[82:83] op_sel:[1,0,0] op_sel_hi:[1,1,0]
    v_pk_fma_f32 v[120:121], v[82:83], s[78:79], v[82:83] op_sel:[1,0,0] op_sel_hi:[1,1,0]
    v_pk_add_f32 v[98:99], v[98:99], v[34:35]
    v_pk_add_f32 v[100:101], v[100:101], v[34:35]
    v_pk_add_f32 v[102:103], v[102:103], v[34:35]
    v_pk_add_f32 v[104:105], v[104:105], v[34:35]
    v_pk_mul_f32 v[106:107], v[106:107], v[98:99]
    v_pk_mul_f32 v[108:109], v[108:109], v[100:101]
    v_pk_mul_f32 v[110:111], v[110:111], v[102:103]
    v_pk_mul_f32 v[112:113], v[112:113], v[104:105]
    v_pk_fma_f32 v[106:107], v[114:115], v[90:91], v[106:107]
    v_pk_fma_f32 v[108:109], v[116:117], v[92:93], v[108:109]
    v_pk_fma_f32 v[110:111], v[118:119], v[94:95], v[110:111]
    v_pk_fma_f32 v[112:113], v[120:121], v[96:97], v[112:113]
    v_pk_mul_f32 v[90:91], v[90:91], v[98:99]
    v_pk_mul_f32 v[92:93], v[92:93], v[100:101]
    v_pk_mul_f32 v[94:95], v[94:95], v[102:103]
    v_pk_mul_f32 v[96:97], v[96:97], v[104:105]
    v_rcp_f32 v90, v90
    v_rcp_f32 v91, v91
    v_rcp_f32 v92, v92
    v_rcp_f32 v93, v93
    v_rcp_f32 v94, v94
    v_rcp_f32 v95, v95
    v_rcp_f32 v96, v96
    v_rcp_f32 v97, v97
    v_pk_fma_f32 v[38:39], v[106:107], v[90:91], v[38:39]
    v_pk_fma_f32 v[40:41], v[108:109], v[92:93], v[40:41]
    v_pk_fma_f32 v[42:43], v[110:111], v[94:95], v[42:43]
    v_pk_fma_f32 v[44:45], v[112:113], v[96:97], v[44:45]
    s_nop 0
    v_permlane32_swap_b32 v38, v42
    v_permlane32_swap_b32 v39, v43
    v_permlane32_swap_b32 v40, v44
    v_permlane32_swap_b32 v41, v45
    v_add_f32 v38, v38, v42
    v_add_f32 v39, v39, v43
    v_add_f32 v40, v40, v44
    v_add_f32 v41, v41, v45
    s_nop 0
    v_permlane16_swap_b32 v38, v40
    v_permlane16_swap_b32 v39, v41
    v_add_f32 v38, v38, v40
    v_add_f32 v39, v39, v41
    s_nop 0
    v_add_f32_dpp v38, v38, v38 row_ror:8 row_mask:0xf bank_mask:0xf
    v_add_f32_dpp v39, v39, v39 row_ror:8 row_mask:0xf bank_mask:0xf
    s_nop 0
    v_add_f32_dpp v38, v38, v38 row_ror:4 row_mask:0xf bank_mask:0xf
    v_add_f32_dpp v39, v39, v39 row_ror:4 row_mask:0xf bank_mask:0xf
    s_nop 0
    v_add_f32_dpp v38, v38, v38 row_ror:2 row_mask:0xf bank_mask:0xf
    v_add_f32_dpp v39, v39, v39 row_ror:2 row_mask:0xf bank_mask:0xf
    s_nop 0
    v_add_f32_dpp v38, v38, v38 row_ror:1 row_mask:0xf bank_mask:0xf
    v_add_f32_dpp v39, v39, v39 row_ror:1 row_mask:0xf bank_mask:0xf
    s_mov_b32 exec_lo, 0x00010001
    s_mov_b32 exec_hi, 0x00010001
    ds_add_f32 v36, v38 offset:128
    ds_add_f32 v36, v39 offset:132
    s_mov_b64 exec, -1
    v_add_u32 v36, 32, v36
    s_add_u32 s8, s8, 524288
    s_add_u32 s9, s9, 1
    s_cmp_lt_u32 s9, 3
    s_cbranch_scc1 L_tabl
    v_mov_b32 v6, 1
    v_mov_b32 v7, 0
    v_lshlrev_b32 v28, 4, v1
    s_mov_b64 exec, 1
    ds_add_rtn_u32 v6, v7, v6 offset:52
    s_mov_b64 exec, -1
    ds_read_b128 v[40:43], v28 offset:128
    s_waitcnt lgkmcnt(0)
    v_readfirstlane_b32 s7, v6
    s_cmp_lg_u32 s7, 7
    s_nop 2
    s_cbranch_scc1 L_tabd
    s_lshl_b32 s8, s46, 16
    v_mul_f32 v40, v40, v34
    v_mul_f32 v41, v41, v34
    v_mul_f32 v42, v42, v34
    v_mul_f32 v43, v43, v34
    v_cvt_pk_bf16_f32 v40, 0, v40
    v_cvt_pk_bf16_f32 v41, 0, v41
    v_cvt_pk_bf16_f32 v42, 0, v42
    v_cvt_pk_bf16_f32 v43, 0, v43
    v_add_f32 v40, s8, v40
    v_add_f32 v41, s8, v41
    v_add_f32 v42, s8, v42
    v_add_f32 v43, s8, v43
    v_cvt_pk_bf16_f32 v40, v40, v41
    v_cvt_pk_bf16_f32 v42, v42, v43
    v_mov_b32 v41, s26
    v_mov_b32 v43, s26
    s_lshl_b32 s7, s2, 7
    s_add_u32 s7, s7, 458752
    s_mov_b64 exec, 0xff
    buffer_store_dwordx4 v[40:43], v28, s[56:59], s7 offen sc1
    s_mov_b64 exec, -1
    s_nop 1
L_tabd:
    s_setprio 2
    s_cmp_eq_u32 s47, 2
    s_cselect_b32 s47, 1, s47
    s_cbranch_scc1 L_vtick
    s_cmp_gt_u32 s3, 3
    s_cbranch_scc1 L_stream
    s_branch L_vtick
L_miss:
    s_ff1_i32_b64 s7, s[72:73]
    s_ff1_i32_b64 s8, s[74:75]
    s_and_b32 s7, s7, 63
    s_and_b32 s8, s8, 63
    v_readlane_b32 s7, v62, s7
    v_readlane_b32 s8, v63, s8
    s_cmp_lg_u64 s[72:73], 0
    s_cselect_b32 s9, s7, s8
    v_lshlrev_b32 v16, 2, v1
    v_mov_b32 v17, 0
    v_mov_b32 v18, 0xc0135761
    v_mov_b32 v19, 0xbdd2d3e8
    s_mov_b32 s7, 0
L_missl:
    s_mov_b32 s60, s28
    s_mov_b32 s61, s29
    s_mov_b32 s62, 7168
    s_mov_b32 s63, 0x20000
    buffer_load_dword v128, v16, s[60:63], s7 offen offset:0
    buffer_load_dword v129, v16, s[60:63], s7 offen offset:256
    buffer_load_dword v130, v16, s[60:63], s7 offen offset:512
    buffer_load_dword v131, v16, s[60:63], s7 offen offset:768
    buffer_load_dword v132, v16, s[60:63], s7 offen offset:1024
    buffer_load_dword v133, v16, s[60:63], s7 offen offset:1280
    buffer_load_dword v134, v16, s[60:63], s7 offen offset:1536
    s_mov_b32 s60, s30
    s_mov_b32 s61, s31
    s_mov_b32 s62, 7168
    s_mov_b32 s63, 0x20000
    buffer_load_dword v136, v16, s[60:63], s7 offen offset:0
    buffer_load_dword v137, v16, s[60:63], s7 offen offset:256
    buffer_load_dword v138, v16, s[60:63], s7 offen offset:512
    buffer_load_dword v139, v16, s[60:63], s7 offen offset:768
    buffer_load_dword v140, v16, s[60:63], s7 offen offset:1024
    buffer_load_dword v141, v16, s[60:63], s7 offen offset:1280
    buffer_load_dword v142, v16, s[60:63], s7 offen offset:1536
    s_mov_b32 s60, s32
    s_mov_b32 s61, s33
    s_mov_b32 s62, 7168
    s_mov_b32 s63, 0x20000
    buffer_load_dword v144, v16, s[60:63], s7 offen offset:0
    buffer_load_dword v145, v16, s[60:63], s7 offen offset:256
    buffer_load_dword v146, v16, s[60:63], s7 offen offset:512
    buffer_load_dword v147, v16, s[60:63], s7 offen offset:768
    buffer_load_dword v148, v16, s[60:63], s7 offen offset:1024
    buffer_load_dword v149, v16, s[60:63], s7 offen offset:1280
    buffer_load_dword v150, v16, s[60:63], s7 offen offset:1536
    s_waitcnt vmcnt(0)
    v_lshlrev_b32 v20, 16, v128
    v_lshlrev_b32 v21, 16, v136
    v_lshlrev_b32 v22, 16, v144
    v_fma_f32 v20, v20, s9, v21
    v_mul_f32 v21, v20, v20
    v_fma_f32 v21, v21, v19, v18
    v_mul_f32 v21, v21, v20
    v_exp_f32 v21, v21
    v_mul_f32 v20, v20, v22
    v_add_f32 v21, 1.0, v21
    v_rcp_f32 v21, v21
    s_nop 0
    v_fmac_f32 v17, v20, v21
    v_and_b32 v20, 0xffff0000, v128
    v_and_b32 v21, 0xffff0000, v136
    v_and_b32 v22, 0xffff0000, v144
    v_fma_f32 v20, v20, s9, v21
    v_mul_f32 v21, v20, v20
    v_fma_f32 v21, v21, v19, v18
    v_mul_f32 v21, v21, v20
    v_exp_f32 v21, v21
    v_mul_f32 v20, v20, v22
    v_add_f32 v21, 1.0, v21
    v_rcp_f32 v21, v21
    s_nop 0
    v_fmac_f32 v17, v20, v21
    v_lshlrev_b32 v20, 16, v129
    v_lshlrev_b32 v21, 16, v137
    v_lshlrev_b32 v22, 16, v145
    v_fma_f32 v20, v20, s9, v21
    v_mul_f32 v21, v20, v20
    v_fma_f32 v21, v21, v19, v18
    v_mul_f32 v21, v21, v20
    v_exp_f32 v21, v21
    v_mul_f32 v20, v20, v22
    v_add_f32 v21, 1.0, v21
    v_rcp_f32 v21, v21
    s_nop 0
    v_fmac_f32 v17, v20, v21
    v_and_b32 v20, 0xffff0000, v129
    v_and_b32 v21, 0xffff0000, v137
    v_and_b32 v22, 0xffff0000, v145
    v_fma_f32 v20, v20, s9, v21
    v_mul_f32 v21, v20, v20
    v_fma_f32 v21, v21, v19, v18
    v_mul_f32 v21, v21, v20
    v_exp_f32 v21, v21
    v_mul_f32 v20, v20, v22
    v_add_f32 v21, 1.0, v21
    v_rcp_f32 v21, v21
    s_nop 0
    v_fmac_f32 v17, v20, v21
    v_lshlrev_b32 v20, 16, v130
    v_lshlrev_b32 v21, 16, v138
    v_lshlrev_b32 v22, 16, v146
    v_fma_f32 v20, v20, s9, v21
    v_mul_f32 v21, v20, v20
    v_fma_f32 v21, v21, v19, v18
    v_mul_f32 v21, v21, v20
    v_exp_f32 v21, v21
    v_mul_f32 v20, v20, v22
    v_add_f32 v21, 1.0, v21
    v_rcp_f32 v21, v21
    s_nop 0
    v_fmac_f32 v17, v20, v21
    v_and_b32 v20, 0xffff0000, v130
    v_and_b32 v21, 0xffff0000, v138
    v_and_b32 v22, 0xffff0000, v146
    v_fma_f32 v20, v20, s9, v21
    v_mul_f32 v21, v20, v20
    v_fma_f32 v21, v21, v19, v18
    v_mul_f32 v21, v21, v20
    v_exp_f32 v21, v21
    v_mul_f32 v20, v20, v22
    v_add_f32 v21, 1.0, v21
    v_rcp_f32 v21, v21
    s_nop 0
    v_fmac_f32 v17, v20, v21
    v_lshlrev_b32 v20, 16, v131
    v_lshlrev_b32 v21, 16, v139
    v_lshlrev_b32 v22, 16, v147
    v_fma_f32 v20, v20, s9, v21
    v_mul_f32 v21, v20, v20
    v_fma_f32 v21, v21, v19, v18
    v_mul_f32 v21, v21, v20
    v_exp_f32 v21, v21
    v_mul_f32 v20, v20, v22
    v_add_f32 v21, 1.0, v21
    v_rcp_f32 v21, v21
    s_nop 0
    v_fmac_f32 v17, v20, v21
    v_and_b32 v20, 0xffff0000, v131
    v_and_b32 v21, 0xffff0000, v139
    v_and_b32 v22, 0xffff0000, v147
    v_fma_f32 v20, v20, s9, v21
    v_mul_f32 v21, v20, v20
    v_fma_f32 v21, v21, v19, v18
    v_mul_f32 v21, v21, v20
    v_exp_f32 v21, v21
    v_mul_f32 v20, v20, v22
    v_add_f32 v21, 1.0, v21
    v_rcp_f32 v21, v21
    s_nop 0
    v_fmac_f32 v17, v20, v21
    v_lshlrev_b32 v20, 16, v132
    v_lshlrev_b32 v21, 16, v140
    v_lshlrev_b32 v22, 16, v148
    v_fma_f32 v20, v20, s9, v21
    v_mul_f32 v21, v20, v20
    v_fma_f32 v21, v21, v19, v18
    v_mul_f32 v21, v21, v20
    v_exp_f32 v21, v21
    v_mul_f32 v20, v20, v22
    v_add_f32 v21, 1.0, v21
    v_rcp_f32 v21, v21
    s_nop 0
    v_fmac_f32 v17, v20, v21
    v_and_b32 v20, 0xffff0000, v132
    v_and_b32 v21, 0xffff0000, v140
    v_and_b32 v22, 0xffff0000, v148
    v_fma_f32 v20, v20, s9, v21
    v_mul_f32 v21, v20, v20
    v_fma_f32 v21, v21, v19, v18
    v_mul_f32 v21, v21, v20
    v_exp_f32 v21, v21
    v_mul_f32 v20, v20, v22
    v_add_f32 v21, 1.0, v21
    v_rcp_f32 v21, v21
    s_nop 0
    v_fmac_f32 v17, v20, v21
    v_lshlrev_b32 v20, 16, v133
    v_lshlrev_b32 v21, 16, v141
    v_lshlrev_b32 v22, 16, v149
    v_fma_f32 v20, v20, s9, v21
    v_mul_f32 v21, v20, v20
    v_fma_f32 v21, v21, v19, v18
    v_mul_f32 v21, v21, v20
    v_exp_f32 v21, v21
    v_mul_f32 v20, v20, v22
    v_add_f32 v21, 1.0, v21
    v_rcp_f32 v21, v21
    s_nop 0
    v_fmac_f32 v17, v20, v21
    v_and_b32 v20, 0xffff0000, v133
    v_and_b32 v21, 0xffff0000, v141
    v_and_b32 v22, 0xffff0000, v149
    v_fma_f32 v20, v20, s9, v21
    v_mul_f32 v21, v20, v20
    v_fma_f32 v21, v21, v19, v18
    v_mul_f32 v21, v21, v20
    v_exp_f32 v21, v21
    v_mul_f32 v20, v20, v22
    v_add_f32 v21, 1.0, v21
    v_rcp_f32 v21, v21
    s_nop 0
    v_fmac_f32 v17, v20, v21
    v_lshlrev_b32 v20, 16, v134
    v_lshlrev_b32 v21, 16, v142
    v_lshlrev_b32 v22, 16, v150
    v_fma_f32 v20, v20, s9, v21
    v_mul_f32 v21, v20, v20
    v_fma_f32 v21, v21, v19, v18
    v_mul_f32 v21, v21, v20
    v_exp_f32 v21, v21
    v_mul_f32 v20, v20, v22
    v_add_f32 v21, 1.0, v21
    v_rcp_f32 v21, v21
    s_nop 0
    v_fmac_f32 v17, v20, v21
    v_and_b32 v20, 0xffff0000, v134
    v_and_b32 v21, 0xffff0000, v142
    v_and_b32 v22, 0xffff0000, v150
    v_fma_f32 v20, v20, s9, v21
    v_mul_f32 v21, v20, v20
    v_fma_f32 v21, v21, v19, v18
    v_mul_f32 v21, v21, v20
    v_exp_f32 v21, v21
    v_mul_f32 v20, v20, v22
    v_add_f32 v21, 1.0, v21
    v_rcp_f32 v21, v21
    s_nop 0
    v_fmac_f32 v17, v20, v21
    s_add_u32 s7, s7, 1792
    s_cmp_lt_u32 s7, 7168
    s_cbranch_scc1 L_missl
    v_add_f32_dpp v17, v17, v17 row_ror:8 row_mask:0xf bank_mask:0xf
    s_nop 1
    v_add_f32_dpp v17, v17, v17 row_ror:4 row_mask:0xf bank_mask:0xf
    s_nop 1
    v_add_f32_dpp v17, v17, v17 row_ror:2 row_mask:0xf bank_mask:0xf
    s_nop 1
    v_add_f32_dpp v17, v17, v17 row_ror:1 row_mask:0xf bank_mask:0xf
    v_mov_b32 v20, v17
    s_nop 1
    v_permlane16_swap_b32 v17, v20
    v_add_f32 v17, v17, v20
    v_mov_b32 v20, v17
    s_nop 1
    v_permlane32_swap_b32 v17, v20
    v_add_f32 v17, v17, v20
    v_cvt_pk_bf16_f32 v17, 0, v17
    s_lshl_b32 s7, s46, 16
    v_add_f32 v17, s7, v17
    v_cvt_pk_bf16_f32 v17, 0, v17
    v_cmp_eq_u32 vcc, s9, v62
    s_nop 1
    v_cndmask_b32 v60, v60, v17, vcc
    s_andn2_b64 s[72:73], s[72:73], vcc
    v_cmp_eq_u32 vcc, s9, v63
    s_nop 1
    v_cndmask_b32 v61, v61, v17, vcc
    s_andn2_b64 s[74:75], s[74:75], vcc
    s_or_b64 vcc, s[72:73], s[74:75]
    s_cbranch_scc1 L_miss
    s_branch L_out
L_end:
    s_endpgm
.section .rodata,"a"
.p2align 6
.amdhsa_kernel adaLN_cond__gqa_block_cached__mixer_token_mlp__decode_kernel
  .amdhsa_next_free_vgpr 256
  .amdhsa_next_free_sgpr 102
  .amdhsa_accum_offset 256
  .amdhsa_group_segment_fixed_size 0
  .amdhsa_kernarg_size 120
  .amdhsa_user_sgpr_count 2
  .amdhsa_user_sgpr_kernarg_segment_ptr 1
  .amdhsa_system_sgpr_workgroup_id_x 1
  .amdhsa_float_denorm_mode_32 3
.end_amdhsa_kernel
```
